```python
import torch

def _softmax(x, axis=-1):
    return torch.softmax(x, dim=axis)
def _gelu(x):
    return torch.nn.functional.gelu(x, approximate="tanh")
def _silu(x):
    return torch.nn.functional.silu(x)
def _sigmoid(x):
    return torch.sigmoid(x)
def _layernorm(x, axis=-1, eps=1e-5):
    m = x.mean(dim=axis, keepdim=True)
    v = x.var(dim=axis, keepdim=True, unbiased=False)
    return (x - m) / torch.sqrt(v + eps)
def _scatter_add(tgt, idx, src, axis=0):
    return tgt.clone().index_add_(axis, idx, src)
def _segment_sum(src, seg, n):
    out = torch.zeros((n,) + src.shape[1:], dtype=src.dtype)
    return out.index_add_(0, seg, src)
def _pad(x, pw):
    flat = tuple(v for pair in reversed(pw) for v in pair)
    return torch.nn.functional.pad(x, flat)

kernel_name = 'interleave_layers__linear_kernel_hedgehog__mixer_s_mlp__prompt'

def setup_inputs():

    _w = (lambda a: (lambda t: t.to(torch.bfloat16) if t.is_floating_point() else t)(torch.as_tensor(a)))
    def _A_setup():
        B, S, D, H = 1, 2048, 448, 16
        Dh = D // H
        return {
            "x": _w((lambda *s: torch.randn(*s, dtype=torch.bfloat16) * 0.05)(B, S, D)),
            "wqkv": _w((lambda *s: torch.randn(*s, dtype=torch.bfloat16) * 0.4)(D, 3 * D)),
            "w_phi": _w((lambda *s: torch.randn(*s, dtype=torch.bfloat16) * 0.4)(H, Dh, Dh) * (Dh ** -0.5)),
            "wo": _w((lambda *s: torch.randn(*s, dtype=torch.bfloat16) * 0.05)(D, D)),
        }
    _A_in = _A_setup()

    def _B_setup():
        B, S, D, F = 1, 2048, 448, 1792
        return {
            "x":  _w((lambda *s: torch.randn(*s, dtype=torch.bfloat16) * 0.05)(B, S, D)),
            "w1": _w((lambda *s: torch.randn(*s, dtype=torch.bfloat16) * 3.2)(D, D) * (D ** -0.5)),
            "w2": _w((lambda *s: torch.randn(*s, dtype=torch.bfloat16) * 3.2)(D, D) * (D ** -0.5)),
            "w3": _w((lambda *s: torch.randn(*s, dtype=torch.bfloat16) * 3.2)(D, F) * (D ** -0.5)),
            "w4": _w((lambda *s: torch.randn(*s, dtype=torch.bfloat16) * 3.2)(F, D) * (F ** -0.5)),
        }
    _B_in = _B_setup()

    return {
        "A_x": _A_in["x"],
        "A_wqkv": _A_in["wqkv"],
        "A_w_phi": _A_in["w_phi"],
        "A_wo": _A_in["wo"],
        "B_x": _B_in["x"],
        "B_w1": _B_in["w1"],
        "B_w2": _B_in["w2"],
        "B_w3": _B_in["w3"],
        "B_w4": _B_in["w4"],
    }

def reference(A_x, A_wqkv, A_w_phi, A_wo, B_x, B_w1, B_w2, B_w3, B_w4):
    def _A_ref(x, wqkv, w_phi, wo):
        B, S, D = x.shape
        H = 16; Dh = D // H
        qkv = (lambda x, *d: x.permute(*d))((x @ wqkv).reshape(B, S, 3, H, Dh), 2, 0, 3, 1, 4)
        q, k, v = qkv[0], qkv[1], qkv[2]
        pq = torch.einsum("bhsd,hdf->bhsf", q, w_phi)
        pk = torch.einsum("bhsd,hdf->bhsf", k, w_phi)
        phi_q = torch.concatenate([_softmax(pq, axis=-1), _softmax(-pq, axis=-1)], axis=-1)
        phi_k = torch.concatenate([_softmax(pk, axis=-1), _softmax(-pk, axis=-1)], axis=-1)
        kv = torch.einsum("bhsf,bhsd->bhfd", phi_k, v)
        z  = torch.einsum("bhsf->bhf", phi_k)
        num = torch.einsum("bhqf,bhfd->bhqd", phi_q, kv)
        den = torch.einsum("bhqf,bhf->bhq", phi_q, z)[..., None] + 1e-6
        o = num / den
        return (lambda x, *d: x.permute(*d))(o, 0, 2, 1, 3).reshape(B, S, D) @ wo

    def _B_ref(x, w1, w2, w3, w4):
        B, S, D = x.shape
        h = _gelu(_layernorm(x, axis=-1) @ w1)
        c = D // 4
        g0 = _pad(h[:, :, 0*c:1*c], ((0, 0), (1, 0), (0, 0)))[:, :S, :]
        g1 = _pad(h[:, :, 1*c:2*c], ((0, 0), (0, 1), (0, 0)))[:, 1:, :]
        g2 = _pad(h[:, :, 2*c:3*c], ((0, 0), (2, 0), (0, 0)))[:, :S, :]
        g3 = _pad(h[:, :, 3*c:   ], ((0, 0), (0, 2), (0, 0)))[:, 2:, :]
        hs = torch.concatenate([g0, g1, g2, g3], axis=-1) @ w2
        x1 = x + hs
        h2 = _gelu(_layernorm(x1, axis=-1) @ w3) @ w4
        return x1 + h2

    x = A_x
    x = x + _A_ref(_layernorm(x, axis=-1), A_wqkv, A_w_phi, A_wo)
    x = x + _B_ref(_layernorm(x, axis=-1), B_w1, B_w2, B_w3, B_w4)
    x = x + _A_ref(_layernorm(x, axis=-1), A_wqkv, A_w_phi, A_wo)
    x = x + _B_ref(_layernorm(x, axis=-1), B_w1, B_w2, B_w3, B_w4)
    return x
```

```asm
; @launch grid=(256,1,1) block=(512,1,1) lds=163840
.amdgcn_target "amdgcn-amd-amdhsa--gfx950"
.text
.p2align 8
.globl interleave_layers__linear_kernel_hedgehog__mixer_s_mlp__prompt_kernel
.type interleave_layers__linear_kernel_hedgehog__mixer_s_mlp__prompt_kernel,@function
interleave_layers__linear_kernel_hedgehog__mixer_s_mlp__prompt_kernel:
    s_cmp_ge_u32 s2, 256
    s_cbranch_scc1 L_end
    s_load_dwordx16 s[16:31], s[0:1], 0x0
    s_load_dwordx8 s[32:39], s[0:1], 0x40
    s_and_b32 s10, s2, 7
    s_lshr_b32 s11, s2, 3
    s_and_b32 s12, s11, 1
    s_lshl_b32 s12, s12, 3
    s_add_u32 s3, s10, s12
    s_lshr_b32 s4, s11, 1
    s_mul_i32 s12, s11, 37
    s_lshr_b32 s12, s12, 8
    s_mul_i32 s13, s12, 7
    s_sub_u32 s7, s11, s13
    s_lshr_b32 s13, s12, 1
    s_lshl_b32 s13, s13, 3
    s_add_u32 s13, s13, s10
    s_lshl_b32 s13, s13, 1
    s_and_b32 s6, s12, 1
    s_add_u32 s6, s6, s13
    s_cmp_lt_u32 s11, 28
    s_cselect_b32 s74, 1, 0
    v_and_b32 v1, 63, v0
    v_and_b32 v2, 15, v1
    v_lshrrev_b32 v3, 4, v1
    v_bfe_u32 v4, v1, 2, 2
    v_and_b32 v5, 3, v1
    v_lshrrev_b32 v6, 6, v0
    s_nop 0
    v_readfirstlane_b32 s5, v6
    s_mov_b32 s60, 0
    s_mov_b32 s61, 0xffff0000
    v_add_u32 v8, 0, v1
    v_mul_u32_u24 v9, 293, v8
    v_lshrrev_b32 v9, 14, v9
    v_mul_u32_u24 v10, 56, v9
    v_sub_u32 v8, v8, v10
    v_lshrrev_b32 v10, 1, v9
    v_xor_b32 v8, v8, v10
    v_lshlrev_b32 v8, 4, v8
    v_mul_u32_u24 v9, 896, v9
    v_add_u32 v236, v8, v9
    v_add_u32 v8, 64, v1
    v_mul_u32_u24 v9, 293, v8
    v_lshrrev_b32 v9, 14, v9
    v_mul_u32_u24 v10, 56, v9
    v_sub_u32 v8, v8, v10
    v_lshrrev_b32 v10, 1, v9
    v_xor_b32 v8, v8, v10
    v_lshlrev_b32 v8, 4, v8
    v_mul_u32_u24 v9, 896, v9
    v_add_u32 v237, v8, v9
    v_add_u32 v8, 128, v1
    v_mul_u32_u24 v9, 293, v8
    v_lshrrev_b32 v9, 14, v9
    v_mul_u32_u24 v10, 56, v9
    v_sub_u32 v8, v8, v10
    v_lshrrev_b32 v10, 1, v9
    v_xor_b32 v8, v8, v10
    v_lshlrev_b32 v8, 4, v8
    v_mul_u32_u24 v9, 896, v9
    v_add_u32 v238, v8, v9
    v_add_u32 v8, 192, v1
    v_mul_u32_u24 v9, 293, v8
    v_lshrrev_b32 v9, 14, v9
    v_mul_u32_u24 v10, 56, v9
    v_sub_u32 v8, v8, v10
    v_lshrrev_b32 v10, 1, v9
    v_xor_b32 v8, v8, v10
    v_lshlrev_b32 v8, 4, v8
    v_mul_u32_u24 v9, 896, v9
    v_add_u32 v239, v8, v9
    v_add_u32 v8, 256, v1
    v_mul_u32_u24 v9, 293, v8
    v_lshrrev_b32 v9, 14, v9
    v_mul_u32_u24 v10, 56, v9
    v_sub_u32 v8, v8, v10
    v_lshrrev_b32 v10, 1, v9
    v_xor_b32 v8, v8, v10
    v_lshlrev_b32 v8, 4, v8
    v_mul_u32_u24 v9, 896, v9
    v_add_u32 v240, v8, v9
    v_add_u32 v8, 320, v1
    v_mul_u32_u24 v9, 293, v8
    v_lshrrev_b32 v9, 14, v9
    v_mul_u32_u24 v10, 56, v9
    v_sub_u32 v8, v8, v10
    v_lshrrev_b32 v10, 1, v9
    v_xor_b32 v8, v8, v10
    v_lshlrev_b32 v8, 4, v8
    v_mul_u32_u24 v9, 896, v9
    v_add_u32 v241, v8, v9
    v_add_u32 v8, 384, v1
    v_mul_u32_u24 v9, 293, v8
    v_lshrrev_b32 v9, 14, v9
    v_mul_u32_u24 v10, 56, v9
    v_sub_u32 v8, v8, v10
    v_lshrrev_b32 v10, 1, v9
    v_xor_b32 v8, v8, v10
    v_lshlrev_b32 v8, 4, v8
    v_mul_u32_u24 v9, 896, v9
    v_add_u32 v242, v8, v9
    v_lshrrev_b32 v8, 1, v2
    v_xor_b32 v8, v8, v3
    v_mul_u32_u24 v9, 896, v2
    v_lshl_add_u32 v243, v8, 4, v9
    v_xor_b32 v8, 4, v8
    v_lshl_add_u32 v244, v8, 4, v9
    v_mov_b32 v232, 0x3f803f80
    v_mov_b32 v233, 0x3f803f80
    v_mov_b32 v234, 0x3f803f80
    v_mov_b32 v235, 0x3f803f80
    s_waitcnt lgkmcnt(0)
    s_mov_b32 s76, s36
    s_mov_b32 s77, s37
    s_mov_b32 s78, 0x100
    s_mov_b32 s79, 0x00020000
    s_add_u32 s92, s38, 0x3800000
    s_addc_u32 s93, s39, 0
    s_mov_b32 s94, 0x10000
    s_mov_b32 s95, 0x00020000
    s_mov_b32 s90, 0
    s_mov_b32 s91, 0
    s_or_b32 s10, s2, s5
    s_cmp_lg_u32 s10, 0
    s_cbranch_scc1 L_notag
    s_memrealtime s[10:11]
    s_waitcnt lgkmcnt(0)
    s_or_b32 s10, s10, 1
    v_mov_b32 v10, s10
    v_mov_b32 v11, s11
    v_mov_b32 v8, 0
    s_mov_b64 exec, 1
    buffer_store_dwordx2 v[10:11], v8, s[76:79], 0 offen sc1
    s_mov_b64 exec, -1
L_notag:
    s_mov_b32 s64, 0
    s_mov_b32 s75, 0
    s_nop 3
L_layer:
    s_lshl_b32 s10, s64, 25
    s_add_u32 s66, s38, s10
    s_addc_u32 s67, s39, 0
    s_add_u32 s10, s38, 0x1800000
    s_addc_u32 s11, s39, 0
    s_cmp_eq_u32 s64, 0
    s_cselect_b32 s68, s16, s10
    s_cselect_b32 s69, s17, s11
    s_cselect_b32 s70, s10, s34
    s_cselect_b32 s71, s11, s35
    s_mul_i32 s72, s64, 60
    s_lshl_b32 s8, s3, 7
    s_lshl_b32 s9, s5, 4
    s_add_u32 s8, s8, s9
    v_add_u32 v7, s8, v2
    s_mov_b32 s40, s18
    s_mov_b32 s41, s19
    s_mov_b32 s42, 0x126000
    s_mov_b32 s43, 0x00020000
    s_mov_b32 s44, s68
    s_mov_b32 s45, s69
    s_mov_b32 s46, 0x1c0000
    s_mov_b32 s47, 0x00020000
    s_mov_b32 s48, s20
    s_mov_b32 s49, s21
    s_mov_b32 s50, 0x6200
    s_mov_b32 s51, 0x00020000
    s_mov_b32 s52, s66
    s_mov_b32 s53, s67
    s_mov_b32 s54, 0x200000
    s_mov_b32 s55, 0x00020000
    v_and_b32 v8, 255, v0
    v_lshrrev_b32 v9, 3, v8
    v_and_b32 v10, 7, v8
    v_mul_u32_u24 v11, 56, v9
    v_lshl_add_u32 v11, v10, 3, v11
    s_mul_i32 s10, s4, 1568
    v_add_u32 v11, s10, v11
    v_cmp_gt_u32 vcc, 28, v9
    v_cmp_gt_u32 s[62:63], 7, v10
    s_nop 1
    s_and_b64 vcc, vcc, s[62:63]
    v_mov_b32 v12, 0x7fffffff
    v_cndmask_b32 v11, v12, v11, vcc
    buffer_load_dwordx2 v[216:217], v11, s[48:51], 0 offen
    v_lshlrev_b32 v218, 3, v8
    s_cmp_lg_u32 s75, 0
    s_cbranch_scc1 L_s1w_1
    s_mul_i32 s11, s4, 56
    s_lshl_b32 s12, s5, 10
    s_add_u32 s12, s12, 65536
    s_lshl_b32 s10, s5, 6
    v_add_u32 v12, s10, v1
    v_add_u32 v8, 0, v12
    v_mul_u32_u24 v9, 2731, v8
    v_lshrrev_b32 v9, 15, v9
    v_mul_u32_u24 v10, 12, v9
    v_sub_u32 v8, v8, v10
    v_bfe_u32 v10, v9, 3, 1
    v_lshlrev_b32 v10, 1, v10
    v_xor_b32 v8, v8, v10
    s_mov_b32 s10, 2688
    v_mul_lo_u32 v9, v9, s10
    v_lshrrev_b32 v10, 2, v8
    v_mul_u32_u24 v10, 896, v10
    v_and_b32 v8, 3, v8
    v_lshlrev_b32 v8, 4, v8
    v_add3_u32 v9, v9, v10, v8
    s_add_u32 m0, s12, 0
    s_nop 0
    buffer_load_dwordx4 v9, s[40:43], s11 offen lds
    v_add_u32 v8, 512, v12
    v_mul_u32_u24 v9, 2731, v8
    v_lshrrev_b32 v9, 15, v9
    v_mul_u32_u24 v10, 12, v9
    v_sub_u32 v8, v8, v10
    v_bfe_u32 v10, v9, 3, 1
    v_lshlrev_b32 v10, 1, v10
    v_xor_b32 v8, v8, v10
    s_mov_b32 s10, 2688
    v_mul_lo_u32 v9, v9, s10
    v_lshrrev_b32 v10, 2, v8
    v_mul_u32_u24 v10, 896, v10
    v_and_b32 v8, 3, v8
    v_lshlrev_b32 v8, 4, v8
    v_add3_u32 v9, v9, v10, v8
    s_add_u32 m0, s12, 8192
    s_nop 0
    buffer_load_dwordx4 v9, s[40:43], s11 offen lds
    v_add_u32 v8, 1024, v12
    v_mul_u32_u24 v9, 2731, v8
    v_lshrrev_b32 v9, 15, v9
    v_mul_u32_u24 v10, 12, v9
    v_sub_u32 v8, v8, v10
    v_bfe_u32 v10, v9, 3, 1
    v_lshlrev_b32 v10, 1, v10
    v_xor_b32 v8, v8, v10
    s_mov_b32 s10, 2688
    v_mul_lo_u32 v9, v9, s10
    v_lshrrev_b32 v10, 2, v8
    v_mul_u32_u24 v10, 896, v10
    v_and_b32 v8, 3, v8
    v_lshlrev_b32 v8, 4, v8
    v_add3_u32 v9, v9, v10, v8
    s_add_u32 m0, s12, 16384
    s_nop 0
    buffer_load_dwordx4 v9, s[40:43], s11 offen lds
    v_add_u32 v8, 1536, v12
    v_mul_u32_u24 v9, 2731, v8
    v_lshrrev_b32 v9, 15, v9
    v_mul_u32_u24 v10, 12, v9
    v_sub_u32 v8, v8, v10
    v_bfe_u32 v10, v9, 3, 1
    v_lshlrev_b32 v10, 1, v10
    v_xor_b32 v8, v8, v10
    s_mov_b32 s10, 2688
    v_mul_lo_u32 v9, v9, s10
    v_lshrrev_b32 v10, 2, v8
    v_mul_u32_u24 v10, 896, v10
    v_and_b32 v8, 3, v8
    v_lshlrev_b32 v8, 4, v8
    v_add3_u32 v9, v9, v10, v8
    s_add_u32 m0, s12, 24576
    s_nop 0
    buffer_load_dwordx4 v9, s[40:43], s11 offen lds
    v_add_u32 v8, 2048, v12
    v_mul_u32_u24 v9, 2731, v8
    v_lshrrev_b32 v9, 15, v9
    v_mul_u32_u24 v10, 12, v9
    v_sub_u32 v8, v8, v10
    v_bfe_u32 v10, v9, 3, 1
    v_lshlrev_b32 v10, 1, v10
    v_xor_b32 v8, v8, v10
    s_mov_b32 s10, 2688
    v_mul_lo_u32 v9, v9, s10
    v_lshrrev_b32 v10, 2, v8
    v_mul_u32_u24 v10, 896, v10
    v_and_b32 v8, 3, v8
    v_lshlrev_b32 v8, 4, v8
    v_add3_u32 v9, v9, v10, v8
    s_add_u32 m0, s12, 32768
    s_nop 0
    buffer_load_dwordx4 v9, s[40:43], s11 offen lds
    v_add_u32 v8, 2560, v12
    v_mul_u32_u24 v9, 2731, v8
    v_lshrrev_b32 v9, 15, v9
    v_mul_u32_u24 v10, 12, v9
    v_sub_u32 v8, v8, v10
    v_bfe_u32 v10, v9, 3, 1
    v_lshlrev_b32 v10, 1, v10
    v_xor_b32 v8, v8, v10
    s_mov_b32 s10, 2688
    v_mul_lo_u32 v9, v9, s10
    v_lshrrev_b32 v10, 2, v8
    v_mul_u32_u24 v10, 896, v10
    v_and_b32 v8, 3, v8
    v_lshlrev_b32 v8, 4, v8
    v_add3_u32 v9, v9, v10, v8
    s_add_u32 m0, s12, 40960
    s_nop 0
    buffer_load_dwordx4 v9, s[40:43], s11 offen lds
    v_add_u32 v8, 3072, v12
    v_mul_u32_u24 v9, 2731, v8
    v_lshrrev_b32 v9, 15, v9
    v_mul_u32_u24 v10, 12, v9
    v_sub_u32 v8, v8, v10
    v_bfe_u32 v10, v9, 3, 1
    v_lshlrev_b32 v10, 1, v10
    v_xor_b32 v8, v8, v10
    s_mov_b32 s10, 2688
    v_mul_lo_u32 v9, v9, s10
    v_lshrrev_b32 v10, 2, v8
    v_mul_u32_u24 v10, 896, v10
    v_and_b32 v8, 3, v8
    v_lshlrev_b32 v8, 4, v8
    v_add3_u32 v9, v9, v10, v8
    s_add_u32 m0, s12, 49152
    s_nop 0
    buffer_load_dwordx4 v9, s[40:43], s11 offen lds
    v_add_u32 v8, 3584, v12
    v_mul_u32_u24 v9, 2731, v8
    v_lshrrev_b32 v9, 15, v9
    v_mul_u32_u24 v10, 12, v9
    v_sub_u32 v8, v8, v10
    v_bfe_u32 v10, v9, 3, 1
    v_lshlrev_b32 v10, 1, v10
    v_xor_b32 v8, v8, v10
    s_mov_b32 s10, 2688
    v_mul_lo_u32 v9, v9, s10
    v_lshrrev_b32 v10, 2, v8
    v_mul_u32_u24 v10, 896, v10
    v_and_b32 v8, 3, v8
    v_lshlrev_b32 v8, 4, v8
    v_add3_u32 v9, v9, v10, v8
    s_add_u32 m0, s12, 57344
    s_nop 0
    buffer_load_dwordx4 v9, s[40:43], s11 offen lds
    v_add_u32 v8, 4096, v12
    v_mul_u32_u24 v9, 2731, v8
    v_lshrrev_b32 v9, 15, v9
    v_mul_u32_u24 v10, 12, v9
    v_sub_u32 v8, v8, v10
    v_bfe_u32 v10, v9, 3, 1
    v_lshlrev_b32 v10, 1, v10
    v_xor_b32 v8, v8, v10
    s_mov_b32 s10, 2688
    v_mul_lo_u32 v9, v9, s10
    v_lshrrev_b32 v10, 2, v8
    v_mul_u32_u24 v10, 896, v10
    v_and_b32 v8, 3, v8
    v_lshlrev_b32 v8, 4, v8
    v_add3_u32 v9, v9, v10, v8
    s_add_u32 m0, s12, 65536
    s_nop 0
    buffer_load_dwordx4 v9, s[40:43], s11 offen lds
    v_add_u32 v8, 4608, v12
    v_mul_u32_u24 v9, 2731, v8
    v_lshrrev_b32 v9, 15, v9
    v_mul_u32_u24 v10, 12, v9
    v_sub_u32 v8, v8, v10
    v_bfe_u32 v10, v9, 3, 1
    v_lshlrev_b32 v10, 1, v10
    v_xor_b32 v8, v8, v10
    s_mov_b32 s10, 2688
    v_mul_lo_u32 v9, v9, s10
    v_lshrrev_b32 v10, 2, v8
    v_mul_u32_u24 v10, 896, v10
    v_and_b32 v8, 3, v8
    v_lshlrev_b32 v8, 4, v8
    v_add3_u32 v9, v9, v10, v8
    s_add_u32 m0, s12, 73728
    s_nop 0
    buffer_load_dwordx4 v9, s[40:43], s11 offen lds
    s_cmp_ge_u32 s5, 4
    s_cbranch_scc1 L_wdg_2
    v_add_u32 v8, 5120, v12
    v_mul_u32_u24 v9, 2731, v8
    v_lshrrev_b32 v9, 15, v9
    v_mul_u32_u24 v10, 12, v9
    v_sub_u32 v8, v8, v10
    v_bfe_u32 v10, v9, 3, 1
    v_lshlrev_b32 v10, 1, v10
    v_xor_b32 v8, v8, v10
    s_mov_b32 s10, 2688
    v_mul_lo_u32 v9, v9, s10
    v_lshrrev_b32 v10, 2, v8
    v_mul_u32_u24 v10, 896, v10
    v_and_b32 v8, 3, v8
    v_lshlrev_b32 v8, 4, v8
    v_add3_u32 v9, v9, v10, v8
    s_add_u32 m0, s12, 81920
    s_nop 0
    buffer_load_dwordx4 v9, s[40:43], s11 offen lds
L_wdg_2:
L_s1w_1:
    s_mov_b32 s75, 0
    s_cmp_lg_u32 s64, 0
    s_cbranch_scc1 L_s1a_3
    s_mul_i32 s10, s8, 896
    v_lshlrev_b32 v8, 4, v1
    v_add_u32 v8, s10, v8
    s_mov_b32 s10, 0
    buffer_load_dwordx4 v[72:75], v8, s[44:47], s10 offen
    s_mov_b32 s10, 1024
    buffer_load_dwordx4 v[76:79], v8, s[44:47], s10 offen
    s_mov_b32 s10, 2048
    buffer_load_dwordx4 v[80:83], v8, s[44:47], s10 offen
    s_mov_b32 s10, 3072
    buffer_load_dwordx4 v[84:87], v8, s[44:47], s10 offen
    s_mov_b32 s10, 4096
    buffer_load_dwordx4 v[88:91], v8, s[44:47], s10 offen
    s_mov_b32 s10, 5120
    buffer_load_dwordx4 v[92:95], v8, s[44:47], s10 offen
    s_mov_b32 s10, 6144
    buffer_load_dwordx4 v[96:99], v8, s[44:47], s10 offen
    s_mov_b32 s10, 7168
    buffer_load_dwordx4 v[100:103], v8, s[44:47], s10 offen
    s_mov_b32 s10, 8192
    buffer_load_dwordx4 v[104:107], v8, s[44:47], s10 offen
    s_mov_b32 s10, 9216
    buffer_load_dwordx4 v[108:111], v8, s[44:47], s10 offen
    s_mov_b32 s10, 10240
    buffer_load_dwordx4 v[112:115], v8, s[44:47], s10 offen
    s_mov_b32 s10, 11264
    buffer_load_dwordx4 v[116:119], v8, s[44:47], s10 offen
    s_mov_b32 s10, 12288
    buffer_load_dwordx4 v[120:123], v8, s[44:47], s10 offen
    s_mov_b32 s10, 13312
    buffer_load_dwordx4 v[124:127], v8, s[44:47], s10 offen
    s_waitcnt vmcnt(14)
    s_branch L_s1b_4
L_s1a_3:
    s_waitcnt vmcnt(0)
L_s1b_4:
    v_add_u32 v218, 0x25000, v218
    ds_write_b64 v218, v[216:217]
    s_waitcnt lgkmcnt(0)
    s_barrier
    s_sub_u32 s10, s5, 1
    s_cmp_ge_u32 s10, 6
    s_cbranch_scc1 L_cs_5
    v_lshl_add_u32 v8, v3, 3, v4
    v_mul_u32_u24 v8, 192, v8
    v_lshl_add_u32 v8, v5, 3, v8
    v_and_b32 v9, 1, v3
    v_xor_b32 v9, s10, v9
    v_lshl_add_u32 v8, v9, 5, v8
    v_add_u32 v8, 65536, v8
    v_add_u32 v9, 61440, v8
    v_mov_b32 v12, 0
    v_mov_b32 v13, 0
    v_mov_b32 v14, 0
    v_mov_b32 v15, 0
    ds_read_b64_tr_b16 v[128:129], v8 offset:0
    ds_read_b64_tr_b16 v[130:131], v8 offset:768
    ds_read_b64_tr_b16 v[132:133], v8 offset:6144
    ds_read_b64_tr_b16 v[134:135], v8 offset:6912
    ds_read_b64_tr_b16 v[136:137], v8 offset:12288
    ds_read_b64_tr_b16 v[138:139], v8 offset:13056
    ds_read_b64_tr_b16 v[140:141], v8 offset:18432
    ds_read_b64_tr_b16 v[142:143], v8 offset:19200
    ds_read_b64_tr_b16 v[144:145], v8 offset:24576
    ds_read_b64_tr_b16 v[146:147], v8 offset:25344
    ds_read_b64_tr_b16 v[148:149], v8 offset:30720
    ds_read_b64_tr_b16 v[150:151], v8 offset:31488
    ds_read_b64_tr_b16 v[152:153], v8 offset:36864
    ds_read_b64_tr_b16 v[154:155], v8 offset:37632
    s_waitcnt lgkmcnt(0)
    v_mfma_f32_16x16x32_bf16 v[12:15], v[128:131], v[232:235], v[12:15]
    v_mfma_f32_16x16x32_bf16 v[12:15], v[132:135], v[232:235], v[12:15]
    v_mfma_f32_16x16x32_bf16 v[12:15], v[136:139], v[232:235], v[12:15]
    v_mfma_f32_16x16x32_bf16 v[12:15], v[140:143], v[232:235], v[12:15]
    v_mfma_f32_16x16x32_bf16 v[12:15], v[144:147], v[232:235], v[12:15]
    v_mfma_f32_16x16x32_bf16 v[12:15], v[148:151], v[232:235], v[12:15]
    v_mfma_f32_16x16x32_bf16 v[12:15], v[152:155], v[232:235], v[12:15]
    ds_read_b64_tr_b16 v[156:157], v8 offset:43008
    ds_read_b64_tr_b16 v[158:159], v8 offset:43776
    ds_read_b64_tr_b16 v[160:161], v8 offset:49152
    ds_read_b64_tr_b16 v[162:163], v8 offset:49920
    ds_read_b64_tr_b16 v[164:165], v8 offset:55296
    ds_read_b64_tr_b16 v[166:167], v8 offset:56064
    ds_read_b64_tr_b16 v[168:169], v9 offset:0
    ds_read_b64_tr_b16 v[170:171], v9 offset:768
    ds_read_b64_tr_b16 v[172:173], v9 offset:6144
    ds_read_b64_tr_b16 v[174:175], v9 offset:6912
    ds_read_b64_tr_b16 v[176:177], v9 offset:12288
    ds_read_b64_tr_b16 v[178:179], v9 offset:13056
    ds_read_b64_tr_b16 v[180:181], v9 offset:18432
    ds_read_b64_tr_b16 v[182:183], v9 offset:19200
    s_waitcnt lgkmcnt(0)
    v_mfma_f32_16x16x32_bf16 v[12:15], v[156:159], v[232:235], v[12:15]
    v_mfma_f32_16x16x32_bf16 v[12:15], v[160:163], v[232:235], v[12:15]
    v_mfma_f32_16x16x32_bf16 v[12:15], v[164:167], v[232:235], v[12:15]
    v_mfma_f32_16x16x32_bf16 v[12:15], v[168:171], v[232:235], v[12:15]
    v_mfma_f32_16x16x32_bf16 v[12:15], v[172:175], v[232:235], v[12:15]
    v_mfma_f32_16x16x32_bf16 v[12:15], v[176:179], v[232:235], v[12:15]
    v_mfma_f32_16x16x32_bf16 v[12:15], v[180:183], v[232:235], v[12:15]
    s_lshl_b32 s10, s10, 6
    v_lshlrev_b32 v8, 4, v3
    v_add_u32 v8, s10, v8
    v_add_u32 v8, 163328, v8
    s_mov_b32 exec_lo, 0x00010001
    s_mov_b32 exec_hi, 0x00010001
    s_nop 1
    ds_write_b128 v8, v[12:15]
    s_mov_b64 exec, -1
    s_waitcnt lgkmcnt(0)
L_cs_5:
    s_or_b32 s10, s64, s5
    s_cmp_lg_u32 s10, 0
    s_cbranch_scc1 L_zi_6
    s_mov_b32 s56, s38
    s_mov_b32 s57, s39
    s_mov_b32 s58, 0x4000000
    s_mov_b32 s59, 0x00020000
    s_lshl_b32 s10, s4, 13
    s_lshl_b32 s11, s3, 9
    s_add_u32 s10, s10, s11
    v_lshrrev_b32 v8, 5, v1
    v_lshlrev_b32 v8, 25, v8
    v_and_b32 v9, 31, v1
    v_lshl_add_u32 v8, v9, 4, v8
    v_add_u32 v8, s10, v8
    v_mov_b32 v12, 0
    v_mov_b32 v13, 0
    v_mov_b32 v14, 0
    v_mov_b32 v15, 0
    buffer_store_dwordx4 v[12:15], v8, s[56:59], 0 offen sc1
    s_waitcnt vmcnt(0)
L_zi_6:
    s_cmp_eq_u32 s64, 0
    s_cbranch_scc1 L_s1nodep_7
    s_lshl_b32 s62, s3, 1
    s_add_u32 s63, s62, 1
    s_cmp_lg_u32 s5, 0
    s_cbranch_scc1 L_wd_9
    v_mov_b32 v8, s62
    v_mov_b32 v9, s63
    v_cmp_eq_u32 vcc, 1, v3
    s_nop 1
    v_cndmask_b32 v8, v8, v9, vcc
    s_lshl_b32 s10, s64, 3
    s_add_u32 s10, s10, -2
    s_lshl_b32 s10, s10, 12
    v_lshlrev_b32 v8, 7, v8
    v_lshl_add_u32 v8, v2, 3, v8
    v_add_u32 v8, s10, v8
    s_mov_b32 exec_lo, 0x7f007f
    s_mov_b32 exec_hi, 0x0
    s_mov_b32 s15, 0
    s_nop 5
L_poll_10:
    buffer_load_dwordx2 v[10:11], v8, s[92:95], 0 offen sc1
    s_waitcnt vmcnt(0)
    v_cmp_ne_u64 vcc, s[90:91], v[10:11]
    s_add_u32 s15, s15, 1
    s_cmp_gt_u32 s15, 0x40000
    s_cbranch_scc1 L_abort
    s_cmp_eq_u64 vcc, 0
    s_nop 2
    s_cbranch_scc1 L_poll_10_done
    s_sleep 1
    s_branch L_poll_10
L_poll_10_done:
    s_mov_b64 exec, -1
L_wd_9:
    s_barrier
    s_mul_i32 s10, s8, 896
    v_lshlrev_b32 v8, 4, v1
    v_add_u32 v8, s10, v8
    s_mov_b32 s10, 0
    buffer_load_dwordx4 v[72:75], v8, s[44:47], s10 offen
    s_mov_b32 s10, 1024
    buffer_load_dwordx4 v[76:79], v8, s[44:47], s10 offen
    s_mov_b32 s10, 2048
    buffer_load_dwordx4 v[80:83], v8, s[44:47], s10 offen
    s_mov_b32 s10, 3072
    buffer_load_dwordx4 v[84:87], v8, s[44:47], s10 offen
    s_mov_b32 s10, 4096
    buffer_load_dwordx4 v[88:91], v8, s[44:47], s10 offen
    s_mov_b32 s10, 5120
    buffer_load_dwordx4 v[92:95], v8, s[44:47], s10 offen
    s_mov_b32 s10, 6144
    buffer_load_dwordx4 v[96:99], v8, s[44:47], s10 offen
    s_mov_b32 s10, 7168
    buffer_load_dwordx4 v[100:103], v8, s[44:47], s10 offen
    s_mov_b32 s10, 8192
    buffer_load_dwordx4 v[104:107], v8, s[44:47], s10 offen
    s_mov_b32 s10, 9216
    buffer_load_dwordx4 v[108:111], v8, s[44:47], s10 offen
    s_mov_b32 s10, 10240
    buffer_load_dwordx4 v[112:115], v8, s[44:47], s10 offen
    s_mov_b32 s10, 11264
    buffer_load_dwordx4 v[116:119], v8, s[44:47], s10 offen
    s_mov_b32 s10, 12288
    buffer_load_dwordx4 v[120:123], v8, s[44:47], s10 offen
    s_mov_b32 s10, 13312
    buffer_load_dwordx4 v[124:127], v8, s[44:47], s10 offen
    s_branch L_s1j_8
L_s1nodep_7:
    s_barrier
L_s1j_8:
    s_mul_i32 s11, s5, 7168
    s_add_u32 s11, s11, 0
    v_and_b32 v9, 8, v2
    v_mul_u32_u24 v9, 896, v9
    v_sub_u32 v10, v243, v9
    v_sub_u32 v11, v244, v9
    v_add_u32 v10, s11, v10
    v_add_u32 v11, s11, v11
    v_add_u32 v212, s11, v236
    v_add_u32 v213, s11, v237
    v_add_u32 v214, s11, v238
    v_add_u32 v215, s11, v239
    v_add_u32 v216, s11, v240
    v_add_u32 v217, s11, v241
    v_add_u32 v218, s11, v242
    s_waitcnt vmcnt(13)
    ds_write_b128 v212, v[72:75]
    s_waitcnt vmcnt(12)
    ds_write_b128 v213, v[76:79]
    s_waitcnt vmcnt(11)
    ds_write_b128 v214, v[80:83]
    s_waitcnt vmcnt(10)
    ds_write_b128 v215, v[84:87]
    s_waitcnt vmcnt(9)
    ds_write_b128 v216, v[88:91]
    s_waitcnt vmcnt(8)
    ds_write_b128 v217, v[92:95]
    s_waitcnt vmcnt(7)
    ds_write_b128 v218, v[96:99]
    s_waitcnt lgkmcnt(0)
    s_mov_b32 exec_lo, 0x00ff00ff
    s_mov_b32 exec_hi, 0x00ff00ff
    ds_read_b128 v[16:19], v10 offset:0
    ds_read_b128 v[20:23], v11 offset:0
    ds_read_b128 v[24:27], v10 offset:128
    ds_read_b128 v[28:31], v11 offset:128
    ds_read_b128 v[32:35], v10 offset:256
    ds_read_b128 v[36:39], v11 offset:256
    ds_read_b128 v[40:43], v10 offset:384
    ds_read_b128 v[44:47], v11 offset:384
    ds_read_b128 v[48:51], v10 offset:512
    ds_read_b128 v[52:55], v11 offset:512
    ds_read_b128 v[56:59], v10 offset:640
    ds_read_b128 v[60:63], v11 offset:640
    ds_read_b128 v[64:67], v10 offset:768
    ds_read_b128 v[68:71], v11 offset:768
    s_waitcnt lgkmcnt(0)
    s_mov_b64 exec, -1
    v_xor_b32 v212, 64, v236
    v_add_u32 v212, s11, v212
    v_xor_b32 v213, 64, v237
    v_add_u32 v213, s11, v213
    v_xor_b32 v214, 64, v238
    v_add_u32 v214, s11, v214
    v_xor_b32 v215, 64, v239
    v_add_u32 v215, s11, v215
    v_xor_b32 v216, 64, v240
    v_add_u32 v216, s11, v216
    v_xor_b32 v217, 64, v241
    v_add_u32 v217, s11, v217
    v_xor_b32 v218, 64, v242
    v_add_u32 v218, s11, v218
    s_waitcnt vmcnt(6)
    ds_write_b128 v212, v[100:103]
    s_waitcnt vmcnt(5)
    ds_write_b128 v213, v[104:107]
    s_waitcnt vmcnt(4)
    ds_write_b128 v214, v[108:111]
    s_waitcnt vmcnt(3)
    ds_write_b128 v215, v[112:115]
    s_waitcnt vmcnt(2)
    ds_write_b128 v216, v[116:119]
    s_waitcnt vmcnt(1)
    ds_write_b128 v217, v[120:123]
    s_waitcnt vmcnt(0)
    ds_write_b128 v218, v[124:127]
    s_waitcnt lgkmcnt(0)
    s_mov_b32 exec_lo, 0xff00ff00
    s_mov_b32 exec_hi, 0xff00ff00
    ds_read_b128 v[16:19], v10 offset:0
    ds_read_b128 v[20:23], v11 offset:0
    ds_read_b128 v[24:27], v10 offset:128
    ds_read_b128 v[28:31], v11 offset:128
    ds_read_b128 v[32:35], v10 offset:256
    ds_read_b128 v[36:39], v11 offset:256
    ds_read_b128 v[40:43], v10 offset:384
    ds_read_b128 v[44:47], v11 offset:384
    ds_read_b128 v[48:51], v10 offset:512
    ds_read_b128 v[52:55], v11 offset:512
    ds_read_b128 v[56:59], v10 offset:640
    ds_read_b128 v[60:63], v11 offset:640
    ds_read_b128 v[64:67], v10 offset:768
    ds_read_b128 v[68:71], v11 offset:768
    s_waitcnt lgkmcnt(0)
    s_mov_b64 exec, -1
    s_or_b32 s10, s64, s5
    s_cmp_lg_u32 s10, 0
    s_cbranch_scc1 L_zf_11
    s_cmp_lg_u32 s5, 0
    s_cbranch_scc1 L_gt_12
    s_cmp_lg_u32 s90, 0
    s_cbranch_scc1 L_gt_12
    v_mov_b32 v8, 0
    s_mov_b32 s15, 0
    s_nop 3
L_gtp_13:
    buffer_load_dwordx2 v[10:11], v8, s[76:79], 0 offen sc1
    s_waitcnt vmcnt(0)
    v_readfirstlane_b32 s90, v10
    v_readfirstlane_b32 s91, v11
    s_add_u32 s15, s15, 1
    s_cmp_gt_u32 s15, 0x40000
    s_cbranch_scc1 L_abort
    s_cmp_lg_u32 s90, 0
    s_cbranch_scc1 L_gt_12
    s_sleep 2
    s_branch L_gtp_13
L_gt_12:
    s_lshl_b32 s10, s4, 7
    s_lshl_b32 s11, s3, 3
    s_add_u32 s10, s10, s11
    s_add_u32 s10, s10, 28672
    v_mov_b32 v8, s10
    v_mov_b32 v10, s90
    v_mov_b32 v11, s91
    s_mov_b64 exec, 1
    buffer_store_dwordx2 v[10:11], v8, s[92:95], 0 offen sc1
    s_mov_b64 exec, -1
L_zf_11:
    v_lshl_add_u32 v10, v3, 3, v4
    v_mul_u32_u24 v10, 192, v10
    v_lshl_add_u32 v10, v5, 3, v10
    v_add_u32 v10, 0x10000, v10
    v_and_b32 v11, 1, v3
    v_lshlrev_b32 v11, 5, v11
    v_sub_u32 v12, v10, v11
    v_add_u32 v10, v10, v11
    v_mov_b32 v11, v12
    v_add_u32 v212, 0xf000, v10
    v_add_u32 v213, 0xf000, v11
    v_mov_b32 v216, 0
    v_mov_b32 v217, 0
    v_mov_b32 v218, 0
    v_mov_b32 v219, 0
    v_dot2_f32_bf16 v216, v16, v232, v216
    v_dot2_f32_bf16 v218, v16, v16, v218
    v_dot2_f32_bf16 v217, v17, v232, v217
    v_dot2_f32_bf16 v219, v17, v17, v219
    v_dot2_f32_bf16 v216, v18, v232, v216
    v_dot2_f32_bf16 v218, v18, v18, v218
    v_dot2_f32_bf16 v217, v19, v232, v217
    v_dot2_f32_bf16 v219, v19, v19, v219
    v_dot2_f32_bf16 v216, v20, v232, v216
    v_dot2_f32_bf16 v218, v20, v20, v218
    v_dot2_f32_bf16 v217, v21, v232, v217
    v_dot2_f32_bf16 v219, v21, v21, v219
    v_dot2_f32_bf16 v216, v22, v232, v216
    v_dot2_f32_bf16 v218, v22, v22, v218
    v_dot2_f32_bf16 v217, v23, v232, v217
    v_dot2_f32_bf16 v219, v23, v23, v219
    v_dot2_f32_bf16 v216, v24, v232, v216
    v_dot2_f32_bf16 v218, v24, v24, v218
    v_dot2_f32_bf16 v217, v25, v232, v217
    v_dot2_f32_bf16 v219, v25, v25, v219
    v_dot2_f32_bf16 v216, v26, v232, v216
    v_dot2_f32_bf16 v218, v26, v26, v218
    v_dot2_f32_bf16 v217, v27, v232, v217
    v_dot2_f32_bf16 v219, v27, v27, v219
    v_dot2_f32_bf16 v216, v28, v232, v216
    v_dot2_f32_bf16 v218, v28, v28, v218
    v_dot2_f32_bf16 v217, v29, v232, v217
    v_dot2_f32_bf16 v219, v29, v29, v219
    v_dot2_f32_bf16 v216, v30, v232, v216
    v_dot2_f32_bf16 v218, v30, v30, v218
    v_dot2_f32_bf16 v217, v31, v232, v217
    v_dot2_f32_bf16 v219, v31, v31, v219
    v_dot2_f32_bf16 v216, v32, v232, v216
    v_dot2_f32_bf16 v218, v32, v32, v218
    v_dot2_f32_bf16 v217, v33, v232, v217
    v_dot2_f32_bf16 v219, v33, v33, v219
    v_dot2_f32_bf16 v216, v34, v232, v216
    v_dot2_f32_bf16 v218, v34, v34, v218
    v_dot2_f32_bf16 v217, v35, v232, v217
    v_dot2_f32_bf16 v219, v35, v35, v219
    v_dot2_f32_bf16 v216, v36, v232, v216
    v_dot2_f32_bf16 v218, v36, v36, v218
    v_dot2_f32_bf16 v217, v37, v232, v217
    v_dot2_f32_bf16 v219, v37, v37, v219
    v_dot2_f32_bf16 v216, v38, v232, v216
    v_dot2_f32_bf16 v218, v38, v38, v218
    v_dot2_f32_bf16 v217, v39, v232, v217
    v_dot2_f32_bf16 v219, v39, v39, v219
    v_dot2_f32_bf16 v216, v40, v232, v216
    v_dot2_f32_bf16 v218, v40, v40, v218
    v_dot2_f32_bf16 v217, v41, v232, v217
    v_dot2_f32_bf16 v219, v41, v41, v219
    v_dot2_f32_bf16 v216, v42, v232, v216
    v_dot2_f32_bf16 v218, v42, v42, v218
    v_dot2_f32_bf16 v217, v43, v232, v217
    v_dot2_f32_bf16 v219, v43, v43, v219
    v_dot2_f32_bf16 v216, v44, v232, v216
    v_dot2_f32_bf16 v218, v44, v44, v218
    v_dot2_f32_bf16 v217, v45, v232, v217
    v_dot2_f32_bf16 v219, v45, v45, v219
    v_dot2_f32_bf16 v216, v46, v232, v216
    v_dot2_f32_bf16 v218, v46, v46, v218
    v_dot2_f32_bf16 v217, v47, v232, v217
    v_dot2_f32_bf16 v219, v47, v47, v219
    v_dot2_f32_bf16 v216, v48, v232, v216
    v_dot2_f32_bf16 v218, v48, v48, v218
    v_dot2_f32_bf16 v217, v49, v232, v217
    v_dot2_f32_bf16 v219, v49, v49, v219
    v_dot2_f32_bf16 v216, v50, v232, v216
    v_dot2_f32_bf16 v218, v50, v50, v218
    v_dot2_f32_bf16 v217, v51, v232, v217
    v_dot2_f32_bf16 v219, v51, v51, v219
    v_dot2_f32_bf16 v216, v52, v232, v216
    v_dot2_f32_bf16 v218, v52, v52, v218
    v_dot2_f32_bf16 v217, v53, v232, v217
    v_dot2_f32_bf16 v219, v53, v53, v219
    v_dot2_f32_bf16 v216, v54, v232, v216
    v_dot2_f32_bf16 v218, v54, v54, v218
    v_dot2_f32_bf16 v217, v55, v232, v217
    v_dot2_f32_bf16 v219, v55, v55, v219
    v_dot2_f32_bf16 v216, v56, v232, v216
    v_dot2_f32_bf16 v218, v56, v56, v218
    v_dot2_f32_bf16 v217, v57, v232, v217
    v_dot2_f32_bf16 v219, v57, v57, v219
    v_dot2_f32_bf16 v216, v58, v232, v216
    v_dot2_f32_bf16 v218, v58, v58, v218
    v_dot2_f32_bf16 v217, v59, v232, v217
    v_dot2_f32_bf16 v219, v59, v59, v219
    v_dot2_f32_bf16 v216, v60, v232, v216
    v_dot2_f32_bf16 v218, v60, v60, v218
    v_dot2_f32_bf16 v217, v61, v232, v217
    v_dot2_f32_bf16 v219, v61, v61, v219
    v_dot2_f32_bf16 v216, v62, v232, v216
    v_dot2_f32_bf16 v218, v62, v62, v218
    v_dot2_f32_bf16 v217, v63, v232, v217
    v_dot2_f32_bf16 v219, v63, v63, v219
    v_dot2_f32_bf16 v216, v64, v232, v216
    v_dot2_f32_bf16 v218, v64, v64, v218
    v_dot2_f32_bf16 v217, v65, v232, v217
    v_dot2_f32_bf16 v219, v65, v65, v219
    v_dot2_f32_bf16 v216, v66, v232, v216
    v_dot2_f32_bf16 v218, v66, v66, v218
    v_dot2_f32_bf16 v217, v67, v232, v217
    v_dot2_f32_bf16 v219, v67, v67, v219
    v_dot2_f32_bf16 v216, v68, v232, v216
    v_dot2_f32_bf16 v218, v68, v68, v218
    v_dot2_f32_bf16 v217, v69, v232, v217
    v_dot2_f32_bf16 v219, v69, v69, v219
    v_dot2_f32_bf16 v216, v70, v232, v216
    v_dot2_f32_bf16 v218, v70, v70, v218
    v_dot2_f32_bf16 v217, v71, v232, v217
    v_dot2_f32_bf16 v219, v71, v71, v219
    s_nop 1
    v_add_f32 v216, v216, v217
    v_add_f32 v218, v218, v219
    v_mov_b32 v221, v216
    s_nop 1
    v_permlane16_swap_b32 v216, v221
    v_add_f32 v216, v216, v221
    v_mov_b32 v221, v216
    s_nop 1
    v_permlane32_swap_b32 v216, v221
    v_add_f32 v216, v216, v221
    v_mov_b32 v221, v218
    s_nop 1
    v_permlane16_swap_b32 v218, v221
    v_add_f32 v218, v218, v221
    v_mov_b32 v221, v218
    s_nop 1
    v_permlane32_swap_b32 v218, v221
    v_add_f32 v218, v218, v221
    v_mul_f32 v216, 0x3b124925, v216
    v_mul_f32 v218, 0x3b124925, v218
    v_fma_f32 v218, -v216, v216, v218
    v_max_f32 v218, 0, v218
    v_add_f32 v217, 0x3727c5ac, v218
    v_rsq_f32 v217, v217
    s_nop 0
    v_mov_b32 v218, v217
    v_mul_f32 v219, v216, v218
    v_sub_f32 v219, 0, v219
    v_mov_b32 v184, 0
    v_mov_b32 v185, 0
    v_mov_b32 v186, 0
    v_mov_b32 v187, 0
    v_mov_b32 v188, 0
    v_mov_b32 v189, 0
    v_mov_b32 v190, 0
    v_mov_b32 v191, 0
    v_mov_b32 v192, 0
    v_mov_b32 v193, 0
    v_mov_b32 v194, 0
    v_mov_b32 v195, 0
    v_mov_b32 v196, 0
    v_mov_b32 v197, 0
    v_mov_b32 v198, 0
    v_mov_b32 v199, 0
    v_mov_b32 v200, 0
    v_mov_b32 v201, 0
    v_mov_b32 v202, 0
    v_mov_b32 v203, 0
    v_mov_b32 v204, 0
    v_mov_b32 v205, 0
    v_mov_b32 v206, 0
    v_mov_b32 v207, 0
    ds_read_b64_tr_b16 v[128:129], v10 offset:0
    ds_read_b64_tr_b16 v[130:131], v10 offset:768
    ds_read_b64_tr_b16 v[132:133], v11 offset:32
    ds_read_b64_tr_b16 v[134:135], v11 offset:800
    ds_read_b64_tr_b16 v[136:137], v10 offset:64
    ds_read_b64_tr_b16 v[138:139], v10 offset:832
    ds_read_b64_tr_b16 v[140:141], v11 offset:96
    ds_read_b64_tr_b16 v[142:143], v11 offset:864
    ds_read_b64_tr_b16 v[144:145], v10 offset:128
    ds_read_b64_tr_b16 v[146:147], v10 offset:896
    ds_read_b64_tr_b16 v[148:149], v11 offset:160
    ds_read_b64_tr_b16 v[150:151], v11 offset:928
    ds_read_b64_tr_b16 v[152:153], v10 offset:6144
    ds_read_b64_tr_b16 v[154:155], v10 offset:6912
    ds_read_b64_tr_b16 v[156:157], v11 offset:6176
    ds_read_b64_tr_b16 v[158:159], v11 offset:6944
    ds_read_b64_tr_b16 v[160:161], v10 offset:6208
    ds_read_b64_tr_b16 v[162:163], v10 offset:6976
    ds_read_b64_tr_b16 v[164:165], v11 offset:6240
    ds_read_b64_tr_b16 v[166:167], v11 offset:7008
    ds_read_b64_tr_b16 v[168:169], v10 offset:6272
    ds_read_b64_tr_b16 v[170:171], v10 offset:7040
    ds_read_b64_tr_b16 v[172:173], v11 offset:6304
    ds_read_b64_tr_b16 v[174:175], v11 offset:7072
    s_waitcnt lgkmcnt(12)
    v_mfma_f32_16x16x32_bf16 v[184:187], v[128:131], v[16:19], v[184:187]
    v_mfma_f32_16x16x32_bf16 v[188:191], v[132:135], v[16:19], v[188:191]
    v_mfma_f32_16x16x32_bf16 v[192:195], v[136:139], v[16:19], v[192:195]
    v_mfma_f32_16x16x32_bf16 v[196:199], v[140:143], v[16:19], v[196:199]
    v_mfma_f32_16x16x32_bf16 v[200:203], v[144:147], v[16:19], v[200:203]
    v_mfma_f32_16x16x32_bf16 v[204:207], v[148:151], v[16:19], v[204:207]
    ds_read_b64_tr_b16 v[128:129], v10 offset:12288
    ds_read_b64_tr_b16 v[130:131], v10 offset:13056
    ds_read_b64_tr_b16 v[132:133], v11 offset:12320
    ds_read_b64_tr_b16 v[134:135], v11 offset:13088
    ds_read_b64_tr_b16 v[136:137], v10 offset:12352
    ds_read_b64_tr_b16 v[138:139], v10 offset:13120
    ds_read_b64_tr_b16 v[140:141], v11 offset:12384
    ds_read_b64_tr_b16 v[142:143], v11 offset:13152
    ds_read_b64_tr_b16 v[144:145], v10 offset:12416
    ds_read_b64_tr_b16 v[146:147], v10 offset:13184
    ds_read_b64_tr_b16 v[148:149], v11 offset:12448
    ds_read_b64_tr_b16 v[150:151], v11 offset:13216
    s_waitcnt lgkmcnt(12)
    v_mfma_f32_16x16x32_bf16 v[184:187], v[152:155], v[20:23], v[184:187]
    v_mfma_f32_16x16x32_bf16 v[188:191], v[156:159], v[20:23], v[188:191]
    v_mfma_f32_16x16x32_bf16 v[192:195], v[160:163], v[20:23], v[192:195]
    v_mfma_f32_16x16x32_bf16 v[196:199], v[164:167], v[20:23], v[196:199]
    v_mfma_f32_16x16x32_bf16 v[200:203], v[168:171], v[20:23], v[200:203]
    v_mfma_f32_16x16x32_bf16 v[204:207], v[172:175], v[20:23], v[204:207]
    ds_read_b64_tr_b16 v[152:153], v10 offset:18432
    ds_read_b64_tr_b16 v[154:155], v10 offset:19200
    ds_read_b64_tr_b16 v[156:157], v11 offset:18464
    ds_read_b64_tr_b16 v[158:159], v11 offset:19232
    ds_read_b64_tr_b16 v[160:161], v10 offset:18496
    ds_read_b64_tr_b16 v[162:163], v10 offset:19264
    ds_read_b64_tr_b16 v[164:165], v11 offset:18528
    ds_read_b64_tr_b16 v[166:167], v11 offset:19296
    ds_read_b64_tr_b16 v[168:169], v10 offset:18560
    ds_read_b64_tr_b16 v[170:171], v10 offset:19328
    ds_read_b64_tr_b16 v[172:173], v11 offset:18592
    ds_read_b64_tr_b16 v[174:175], v11 offset:19360
    s_waitcnt lgkmcnt(12)
    v_mfma_f32_16x16x32_bf16 v[184:187], v[128:131], v[24:27], v[184:187]
    v_mfma_f32_16x16x32_bf16 v[188:191], v[132:135], v[24:27], v[188:191]
    v_mfma_f32_16x16x32_bf16 v[192:195], v[136:139], v[24:27], v[192:195]
    v_mfma_f32_16x16x32_bf16 v[196:199], v[140:143], v[24:27], v[196:199]
    v_mfma_f32_16x16x32_bf16 v[200:203], v[144:147], v[24:27], v[200:203]
    v_mfma_f32_16x16x32_bf16 v[204:207], v[148:151], v[24:27], v[204:207]
    ds_read_b64_tr_b16 v[128:129], v10 offset:24576
    ds_read_b64_tr_b16 v[130:131], v10 offset:25344
    ds_read_b64_tr_b16 v[132:133], v11 offset:24608
    ds_read_b64_tr_b16 v[134:135], v11 offset:25376
    ds_read_b64_tr_b16 v[136:137], v10 offset:24640
    ds_read_b64_tr_b16 v[138:139], v10 offset:25408
    ds_read_b64_tr_b16 v[140:141], v11 offset:24672
    ds_read_b64_tr_b16 v[142:143], v11 offset:25440
    ds_read_b64_tr_b16 v[144:145], v10 offset:24704
    ds_read_b64_tr_b16 v[146:147], v10 offset:25472
    ds_read_b64_tr_b16 v[148:149], v11 offset:24736
    ds_read_b64_tr_b16 v[150:151], v11 offset:25504
    s_waitcnt lgkmcnt(12)
    v_mfma_f32_16x16x32_bf16 v[184:187], v[152:155], v[28:31], v[184:187]
    v_mfma_f32_16x16x32_bf16 v[188:191], v[156:159], v[28:31], v[188:191]
    v_mfma_f32_16x16x32_bf16 v[192:195], v[160:163], v[28:31], v[192:195]
    v_mfma_f32_16x16x32_bf16 v[196:199], v[164:167], v[28:31], v[196:199]
    v_mfma_f32_16x16x32_bf16 v[200:203], v[168:171], v[28:31], v[200:203]
    v_mfma_f32_16x16x32_bf16 v[204:207], v[172:175], v[28:31], v[204:207]
    ds_read_b64_tr_b16 v[152:153], v10 offset:30720
    ds_read_b64_tr_b16 v[154:155], v10 offset:31488
    ds_read_b64_tr_b16 v[156:157], v11 offset:30752
    ds_read_b64_tr_b16 v[158:159], v11 offset:31520
    ds_read_b64_tr_b16 v[160:161], v10 offset:30784
    ds_read_b64_tr_b16 v[162:163], v10 offset:31552
    ds_read_b64_tr_b16 v[164:165], v11 offset:30816
    ds_read_b64_tr_b16 v[166:167], v11 offset:31584
    ds_read_b64_tr_b16 v[168:169], v10 offset:30848
    ds_read_b64_tr_b16 v[170:171], v10 offset:31616
    ds_read_b64_tr_b16 v[172:173], v11 offset:30880
    ds_read_b64_tr_b16 v[174:175], v11 offset:31648
    s_waitcnt lgkmcnt(12)
    v_mfma_f32_16x16x32_bf16 v[184:187], v[128:131], v[32:35], v[184:187]
    v_mfma_f32_16x16x32_bf16 v[188:191], v[132:135], v[32:35], v[188:191]
    v_mfma_f32_16x16x32_bf16 v[192:195], v[136:139], v[32:35], v[192:195]
    v_mfma_f32_16x16x32_bf16 v[196:199], v[140:143], v[32:35], v[196:199]
    v_mfma_f32_16x16x32_bf16 v[200:203], v[144:147], v[32:35], v[200:203]
    v_mfma_f32_16x16x32_bf16 v[204:207], v[148:151], v[32:35], v[204:207]
    ds_read_b64_tr_b16 v[128:129], v10 offset:36864
    ds_read_b64_tr_b16 v[130:131], v10 offset:37632
    ds_read_b64_tr_b16 v[132:133], v11 offset:36896
    ds_read_b64_tr_b16 v[134:135], v11 offset:37664
    ds_read_b64_tr_b16 v[136:137], v10 offset:36928
    ds_read_b64_tr_b16 v[138:139], v10 offset:37696
    ds_read_b64_tr_b16 v[140:141], v11 offset:36960
    ds_read_b64_tr_b16 v[142:143], v11 offset:37728
    ds_read_b64_tr_b16 v[144:145], v10 offset:36992
    ds_read_b64_tr_b16 v[146:147], v10 offset:37760
    ds_read_b64_tr_b16 v[148:149], v11 offset:37024
    ds_read_b64_tr_b16 v[150:151], v11 offset:37792
    s_waitcnt lgkmcnt(12)
    v_mfma_f32_16x16x32_bf16 v[184:187], v[152:155], v[36:39], v[184:187]
    v_mfma_f32_16x16x32_bf16 v[188:191], v[156:159], v[36:39], v[188:191]
    v_mfma_f32_16x16x32_bf16 v[192:195], v[160:163], v[36:39], v[192:195]
    v_mfma_f32_16x16x32_bf16 v[196:199], v[164:167], v[36:39], v[196:199]
    v_mfma_f32_16x16x32_bf16 v[200:203], v[168:171], v[36:39], v[200:203]
    v_mfma_f32_16x16x32_bf16 v[204:207], v[172:175], v[36:39], v[204:207]
    ds_read_b64_tr_b16 v[152:153], v10 offset:43008
    ds_read_b64_tr_b16 v[154:155], v10 offset:43776
    ds_read_b64_tr_b16 v[156:157], v11 offset:43040
    ds_read_b64_tr_b16 v[158:159], v11 offset:43808
    ds_read_b64_tr_b16 v[160:161], v10 offset:43072
    ds_read_b64_tr_b16 v[162:163], v10 offset:43840
    ds_read_b64_tr_b16 v[164:165], v11 offset:43104
    ds_read_b64_tr_b16 v[166:167], v11 offset:43872
    ds_read_b64_tr_b16 v[168:169], v10 offset:43136
    ds_read_b64_tr_b16 v[170:171], v10 offset:43904
    ds_read_b64_tr_b16 v[172:173], v11 offset:43168
    ds_read_b64_tr_b16 v[174:175], v11 offset:43936
    s_waitcnt lgkmcnt(12)
    v_mfma_f32_16x16x32_bf16 v[184:187], v[128:131], v[40:43], v[184:187]
    v_mfma_f32_16x16x32_bf16 v[188:191], v[132:135], v[40:43], v[188:191]
    v_mfma_f32_16x16x32_bf16 v[192:195], v[136:139], v[40:43], v[192:195]
    v_mfma_f32_16x16x32_bf16 v[196:199], v[140:143], v[40:43], v[196:199]
    v_mfma_f32_16x16x32_bf16 v[200:203], v[144:147], v[40:43], v[200:203]
    v_mfma_f32_16x16x32_bf16 v[204:207], v[148:151], v[40:43], v[204:207]
    ds_read_b64_tr_b16 v[128:129], v10 offset:49152
    ds_read_b64_tr_b16 v[130:131], v10 offset:49920
    ds_read_b64_tr_b16 v[132:133], v11 offset:49184
    ds_read_b64_tr_b16 v[134:135], v11 offset:49952
    ds_read_b64_tr_b16 v[136:137], v10 offset:49216
    ds_read_b64_tr_b16 v[138:139], v10 offset:49984
    ds_read_b64_tr_b16 v[140:141], v11 offset:49248
    ds_read_b64_tr_b16 v[142:143], v11 offset:50016
    ds_read_b64_tr_b16 v[144:145], v10 offset:49280
    ds_read_b64_tr_b16 v[146:147], v10 offset:50048
    ds_read_b64_tr_b16 v[148:149], v11 offset:49312
    ds_read_b64_tr_b16 v[150:151], v11 offset:50080
    s_waitcnt lgkmcnt(12)
    v_mfma_f32_16x16x32_bf16 v[184:187], v[152:155], v[44:47], v[184:187]
    v_mfma_f32_16x16x32_bf16 v[188:191], v[156:159], v[44:47], v[188:191]
    v_mfma_f32_16x16x32_bf16 v[192:195], v[160:163], v[44:47], v[192:195]
    v_mfma_f32_16x16x32_bf16 v[196:199], v[164:167], v[44:47], v[196:199]
    v_mfma_f32_16x16x32_bf16 v[200:203], v[168:171], v[44:47], v[200:203]
    v_mfma_f32_16x16x32_bf16 v[204:207], v[172:175], v[44:47], v[204:207]
    ds_read_b64_tr_b16 v[152:153], v10 offset:55296
    ds_read_b64_tr_b16 v[154:155], v10 offset:56064
    ds_read_b64_tr_b16 v[156:157], v11 offset:55328
    ds_read_b64_tr_b16 v[158:159], v11 offset:56096
    ds_read_b64_tr_b16 v[160:161], v10 offset:55360
    ds_read_b64_tr_b16 v[162:163], v10 offset:56128
    ds_read_b64_tr_b16 v[164:165], v11 offset:55392
    ds_read_b64_tr_b16 v[166:167], v11 offset:56160
    ds_read_b64_tr_b16 v[168:169], v10 offset:55424
    ds_read_b64_tr_b16 v[170:171], v10 offset:56192
    ds_read_b64_tr_b16 v[172:173], v11 offset:55456
    ds_read_b64_tr_b16 v[174:175], v11 offset:56224
    s_waitcnt lgkmcnt(12)
    v_mfma_f32_16x16x32_bf16 v[184:187], v[128:131], v[48:51], v[184:187]
    v_mfma_f32_16x16x32_bf16 v[188:191], v[132:135], v[48:51], v[188:191]
    v_mfma_f32_16x16x32_bf16 v[192:195], v[136:139], v[48:51], v[192:195]
    v_mfma_f32_16x16x32_bf16 v[196:199], v[140:143], v[48:51], v[196:199]
    v_mfma_f32_16x16x32_bf16 v[200:203], v[144:147], v[48:51], v[200:203]
    v_mfma_f32_16x16x32_bf16 v[204:207], v[148:151], v[48:51], v[204:207]
    ds_read_b64_tr_b16 v[128:129], v212 offset:0
    ds_read_b64_tr_b16 v[130:131], v212 offset:768
    ds_read_b64_tr_b16 v[132:133], v213 offset:32
    ds_read_b64_tr_b16 v[134:135], v213 offset:800
    ds_read_b64_tr_b16 v[136:137], v212 offset:64
    ds_read_b64_tr_b16 v[138:139], v212 offset:832
    ds_read_b64_tr_b16 v[140:141], v213 offset:96
    ds_read_b64_tr_b16 v[142:143], v213 offset:864
    ds_read_b64_tr_b16 v[144:145], v212 offset:128
    ds_read_b64_tr_b16 v[146:147], v212 offset:896
    ds_read_b64_tr_b16 v[148:149], v213 offset:160
    ds_read_b64_tr_b16 v[150:151], v213 offset:928
    s_waitcnt lgkmcnt(12)
    v_mfma_f32_16x16x32_bf16 v[184:187], v[152:155], v[52:55], v[184:187]
    v_mfma_f32_16x16x32_bf16 v[188:191], v[156:159], v[52:55], v[188:191]
    v_mfma_f32_16x16x32_bf16 v[192:195], v[160:163], v[52:55], v[192:195]
    v_mfma_f32_16x16x32_bf16 v[196:199], v[164:167], v[52:55], v[196:199]
    v_mfma_f32_16x16x32_bf16 v[200:203], v[168:171], v[52:55], v[200:203]
    v_mfma_f32_16x16x32_bf16 v[204:207], v[172:175], v[52:55], v[204:207]
    ds_read_b64_tr_b16 v[152:153], v212 offset:6144
    ds_read_b64_tr_b16 v[154:155], v212 offset:6912
    ds_read_b64_tr_b16 v[156:157], v213 offset:6176
    ds_read_b64_tr_b16 v[158:159], v213 offset:6944
    ds_read_b64_tr_b16 v[160:161], v212 offset:6208
    ds_read_b64_tr_b16 v[162:163], v212 offset:6976
    ds_read_b64_tr_b16 v[164:165], v213 offset:6240
    ds_read_b64_tr_b16 v[166:167], v213 offset:7008
    ds_read_b64_tr_b16 v[168:169], v212 offset:6272
    ds_read_b64_tr_b16 v[170:171], v212 offset:7040
    ds_read_b64_tr_b16 v[172:173], v213 offset:6304
    ds_read_b64_tr_b16 v[174:175], v213 offset:7072
    s_waitcnt lgkmcnt(12)
    v_mfma_f32_16x16x32_bf16 v[184:187], v[128:131], v[56:59], v[184:187]
    v_mfma_f32_16x16x32_bf16 v[188:191], v[132:135], v[56:59], v[188:191]
    v_mfma_f32_16x16x32_bf16 v[192:195], v[136:139], v[56:59], v[192:195]
    v_mfma_f32_16x16x32_bf16 v[196:199], v[140:143], v[56:59], v[196:199]
    v_mfma_f32_16x16x32_bf16 v[200:203], v[144:147], v[56:59], v[200:203]
    v_mfma_f32_16x16x32_bf16 v[204:207], v[148:151], v[56:59], v[204:207]
    ds_read_b64_tr_b16 v[128:129], v212 offset:12288
    ds_read_b64_tr_b16 v[130:131], v212 offset:13056
    ds_read_b64_tr_b16 v[132:133], v213 offset:12320
    ds_read_b64_tr_b16 v[134:135], v213 offset:13088
    ds_read_b64_tr_b16 v[136:137], v212 offset:12352
    ds_read_b64_tr_b16 v[138:139], v212 offset:13120
    ds_read_b64_tr_b16 v[140:141], v213 offset:12384
    ds_read_b64_tr_b16 v[142:143], v213 offset:13152
    ds_read_b64_tr_b16 v[144:145], v212 offset:12416
    ds_read_b64_tr_b16 v[146:147], v212 offset:13184
    ds_read_b64_tr_b16 v[148:149], v213 offset:12448
    ds_read_b64_tr_b16 v[150:151], v213 offset:13216
    s_waitcnt lgkmcnt(12)
    v_mfma_f32_16x16x32_bf16 v[184:187], v[152:155], v[60:63], v[184:187]
    v_mfma_f32_16x16x32_bf16 v[188:191], v[156:159], v[60:63], v[188:191]
    v_mfma_f32_16x16x32_bf16 v[192:195], v[160:163], v[60:63], v[192:195]
    v_mfma_f32_16x16x32_bf16 v[196:199], v[164:167], v[60:63], v[196:199]
    v_mfma_f32_16x16x32_bf16 v[200:203], v[168:171], v[60:63], v[200:203]
    v_mfma_f32_16x16x32_bf16 v[204:207], v[172:175], v[60:63], v[204:207]
    ds_read_b64_tr_b16 v[152:153], v212 offset:18432
    ds_read_b64_tr_b16 v[154:155], v212 offset:19200
    ds_read_b64_tr_b16 v[156:157], v213 offset:18464
    ds_read_b64_tr_b16 v[158:159], v213 offset:19232
    ds_read_b64_tr_b16 v[160:161], v212 offset:18496
    ds_read_b64_tr_b16 v[162:163], v212 offset:19264
    ds_read_b64_tr_b16 v[164:165], v213 offset:18528
    ds_read_b64_tr_b16 v[166:167], v213 offset:19296
    ds_read_b64_tr_b16 v[168:169], v212 offset:18560
    ds_read_b64_tr_b16 v[170:171], v212 offset:19328
    ds_read_b64_tr_b16 v[172:173], v213 offset:18592
    ds_read_b64_tr_b16 v[174:175], v213 offset:19360
    s_waitcnt lgkmcnt(12)
    v_mfma_f32_16x16x32_bf16 v[184:187], v[128:131], v[64:67], v[184:187]
    v_mfma_f32_16x16x32_bf16 v[188:191], v[132:135], v[64:67], v[188:191]
    v_mfma_f32_16x16x32_bf16 v[192:195], v[136:139], v[64:67], v[192:195]
    v_mfma_f32_16x16x32_bf16 v[196:199], v[140:143], v[64:67], v[196:199]
    v_mfma_f32_16x16x32_bf16 v[200:203], v[144:147], v[64:67], v[200:203]
    v_mfma_f32_16x16x32_bf16 v[204:207], v[148:151], v[64:67], v[204:207]
    s_waitcnt lgkmcnt(0)
    v_mfma_f32_16x16x32_bf16 v[184:187], v[152:155], v[68:71], v[184:187]
    v_mfma_f32_16x16x32_bf16 v[188:191], v[156:159], v[68:71], v[188:191]
    v_mfma_f32_16x16x32_bf16 v[192:195], v[160:163], v[68:71], v[192:195]
    v_mfma_f32_16x16x32_bf16 v[196:199], v[164:167], v[68:71], v[196:199]
    v_mfma_f32_16x16x32_bf16 v[200:203], v[168:171], v[68:71], v[200:203]
    v_mfma_f32_16x16x32_bf16 v[204:207], v[172:175], v[68:71], v[204:207]
    v_lshlrev_b32 v9, 4, v3
    v_add_u32 v9, 163328, v9
    ds_read_b128 v[72:75], v9 offset:0
    ds_read_b128 v[76:79], v9 offset:64
    ds_read_b128 v[80:83], v9 offset:128
    ds_read_b128 v[84:87], v9 offset:192
    ds_read_b128 v[88:91], v9 offset:256
    ds_read_b128 v[92:95], v9 offset:320
    s_waitcnt lgkmcnt(0)
    v_mul_f32 v184, v184, v218
    v_fmac_f32 v184, v72, v219
    v_mul_f32 v185, v185, v218
    v_fmac_f32 v185, v73, v219
    v_mul_f32 v186, v186, v218
    v_fmac_f32 v186, v74, v219
    v_mul_f32 v187, v187, v218
    v_fmac_f32 v187, v75, v219
    v_mul_f32 v188, v188, v218
    v_fmac_f32 v188, v76, v219
    v_mul_f32 v189, v189, v218
    v_fmac_f32 v189, v77, v219
    v_mul_f32 v190, v190, v218
    v_fmac_f32 v190, v78, v219
    v_mul_f32 v191, v191, v218
    v_fmac_f32 v191, v79, v219
    v_mul_f32 v192, v192, v218
    v_fmac_f32 v192, v80, v219
    v_mul_f32 v193, v193, v218
    v_fmac_f32 v193, v81, v219
    v_mul_f32 v194, v194, v218
    v_fmac_f32 v194, v82, v219
    v_mul_f32 v195, v195, v218
    v_fmac_f32 v195, v83, v219
    v_mul_f32 v196, v196, v218
    v_fmac_f32 v196, v84, v219
    v_mul_f32 v197, v197, v218
    v_fmac_f32 v197, v85, v219
    v_mul_f32 v198, v198, v218
    v_fmac_f32 v198, v86, v219
    v_mul_f32 v199, v199, v218
    v_fmac_f32 v199, v87, v219
    v_mul_f32 v200, v200, v218
    v_fmac_f32 v200, v88, v219
    v_mul_f32 v201, v201, v218
    v_fmac_f32 v201, v89, v219
    v_mul_f32 v202, v202, v218
    v_fmac_f32 v202, v90, v219
    v_mul_f32 v203, v203, v218
    v_fmac_f32 v203, v91, v219
    v_mul_f32 v204, v204, v218
    v_fmac_f32 v204, v92, v219
    v_mul_f32 v205, v205, v218
    v_fmac_f32 v205, v93, v219
    v_mul_f32 v206, v206, v218
    v_fmac_f32 v206, v94, v219
    v_mul_f32 v207, v207, v218
    v_fmac_f32 v207, v95, v219
    v_lshl_add_u32 v8, v3, 2, v4
    v_lshlrev_b32 v8, 6, v8
    v_lshl_add_u32 v8, v5, 3, v8
    v_add_u32 v8, 0x25000, v8
    ds_read_b64_tr_b16 v[16:17], v8 offset:0
    ds_read_b64_tr_b16 v[18:19], v8 offset:1024
    ds_read_b64_tr_b16 v[20:21], v8 offset:32
    ds_read_b64_tr_b16 v[22:23], v8 offset:1056
    v_cvt_pk_bf16_f32 v24, v184, v185
    v_cvt_pk_bf16_f32 v28, v192, v193
    v_cvt_pk_bf16_f32 v25, v186, v187
    v_cvt_pk_bf16_f32 v29, v194, v195
    v_cvt_pk_bf16_f32 v26, v188, v189
    v_cvt_pk_bf16_f32 v30, v196, v197
    v_cvt_pk_bf16_f32 v27, v190, v191
    v_cvt_pk_bf16_f32 v31, v198, v199
    v_cndmask_b32 v204, v204, 1.0, s[60:61]
    v_cndmask_b32 v205, v205, 0, s[60:61]
    v_cndmask_b32 v206, v206, 0, s[60:61]
    v_cndmask_b32 v207, v207, 0, s[60:61]
    v_cvt_pk_bf16_f32 v64, v200, v201
    v_cvt_pk_bf16_f32 v65, v202, v203
    v_cvt_pk_bf16_f32 v66, v204, v205
    v_cvt_pk_bf16_f32 v67, v206, v207
    v_mov_b32 v32, 0
    v_mov_b32 v33, 0
    v_mov_b32 v34, 0
    v_mov_b32 v35, 0
    v_mov_b32 v36, 0
    v_mov_b32 v37, 0
    v_mov_b32 v38, 0
    v_mov_b32 v39, 0
    v_mov_b32 v40, 0
    v_mov_b32 v41, 0
    v_mov_b32 v42, 0
    v_mov_b32 v43, 0
    v_mov_b32 v44, 0
    v_mov_b32 v45, 0
    v_mov_b32 v46, 0
    v_mov_b32 v47, 0
    s_waitcnt lgkmcnt(0)
    v_mfma_f32_16x16x32_bf16 v[40:43], v[16:19], v[28:31], v[40:43]
    v_mfma_f32_16x16x32_bf16 v[32:35], v[16:19], v[24:27], v[32:35]
    v_mfma_f32_16x16x32_bf16 v[44:47], v[20:23], v[28:31], v[44:47]
    v_mfma_f32_16x16x32_bf16 v[36:39], v[20:23], v[24:27], v[36:39]
    s_nop 6
    v_cndmask_b32 v44, v44, v40, s[60:61]
    v_cndmask_b32 v45, v45, v40, s[60:61]
    v_cndmask_b32 v46, v46, v40, s[60:61]
    v_cndmask_b32 v47, v47, v40, s[60:61]
    v_max3_f32 v72, v40, v41, v42
    v_max3_f32 v72, v72, v43, v44
    v_max3_f32 v72, v72, v45, v46
    v_max_f32 v72, v72, v47
    v_min3_f32 v73, v40, v41, v42
    v_min3_f32 v73, v73, v43, v44
    v_min3_f32 v73, v73, v45, v46
    v_min_f32 v73, v73, v47
    v_mov_b32 v74, v72
    s_nop 1
    v_permlane16_swap_b32 v72, v74
    v_max_f32 v72, v72, v74
    v_mov_b32 v74, v72
    s_nop 1
    v_permlane32_swap_b32 v72, v74
    v_max_f32 v72, v72, v74
    v_mov_b32 v74, v73
    s_nop 1
    v_permlane16_swap_b32 v73, v74
    v_min_f32 v73, v73, v74
    v_mov_b32 v74, v73
    s_nop 1
    v_permlane32_swap_b32 v73, v74
    v_min_f32 v73, v73, v74
    v_mov_b32 v74, 0x3fb8aa3b
    v_sub_f32 v78, v73, v40
    v_sub_f32 v40, v40, v72
    v_mul_f32 v78, v78, v74
    v_mul_f32 v40, v40, v74
    v_exp_f32 v78, v78
    v_exp_f32 v40, v40
    v_sub_f32 v79, v73, v41
    v_sub_f32 v41, v41, v72
    v_mul_f32 v79, v79, v74
    v_mul_f32 v41, v41, v74
    v_exp_f32 v79, v79
    v_exp_f32 v41, v41
    v_sub_f32 v80, v73, v42
    v_sub_f32 v42, v42, v72
    v_mul_f32 v80, v80, v74
    v_mul_f32 v42, v42, v74
    v_exp_f32 v80, v80
    v_exp_f32 v42, v42
    v_sub_f32 v81, v73, v43
    v_sub_f32 v43, v43, v72
    v_mul_f32 v81, v81, v74
    v_mul_f32 v43, v43, v74
    v_exp_f32 v81, v81
    v_exp_f32 v43, v43
    v_sub_f32 v82, v73, v44
    v_sub_f32 v44, v44, v72
    v_mul_f32 v82, v82, v74
    v_mul_f32 v44, v44, v74
    v_exp_f32 v82, v82
    v_exp_f32 v44, v44
    v_sub_f32 v83, v73, v45
    v_sub_f32 v45, v45, v72
    v_mul_f32 v83, v83, v74
    v_mul_f32 v45, v45, v74
    v_exp_f32 v83, v83
    v_exp_f32 v45, v45
    v_sub_f32 v84, v73, v46
    v_sub_f32 v46, v46, v72
    v_mul_f32 v84, v84, v74
    v_mul_f32 v46, v46, v74
    v_exp_f32 v84, v84
    v_exp_f32 v46, v46
    v_sub_f32 v85, v73, v47
    v_sub_f32 v47, v47, v72
    v_mul_f32 v85, v85, v74
    v_mul_f32 v47, v47, v74
    v_exp_f32 v85, v85
    v_exp_f32 v47, v47
    v_cndmask_b32 v44, v44, 0, s[60:61]
    v_cndmask_b32 v82, v82, 0, s[60:61]
    v_cndmask_b32 v45, v45, 0, s[60:61]
    v_cndmask_b32 v83, v83, 0, s[60:61]
    v_cndmask_b32 v46, v46, 0, s[60:61]
    v_cndmask_b32 v84, v84, 0, s[60:61]
    v_cndmask_b32 v47, v47, 0, s[60:61]
    v_cndmask_b32 v85, v85, 0, s[60:61]
    v_add_f32 v75, v40, v41
    v_add_f32 v76, v78, v79
    v_add_f32 v75, v75, v42
    v_add_f32 v76, v76, v80
    v_add_f32 v75, v75, v43
    v_add_f32 v76, v76, v81
    v_add_f32 v75, v75, v44
    v_add_f32 v76, v76, v82
    v_add_f32 v75, v75, v45
    v_add_f32 v76, v76, v83
    v_add_f32 v75, v75, v46
    v_add_f32 v76, v76, v84
    v_add_f32 v75, v75, v47
    v_add_f32 v76, v76, v85
    v_mov_b32 v74, v75
    s_nop 1
    v_permlane16_swap_b32 v75, v74
    v_add_f32 v75, v75, v74
    v_mov_b32 v74, v75
    s_nop 1
    v_permlane32_swap_b32 v75, v74
    v_add_f32 v75, v75, v74
    v_mov_b32 v74, v76
    s_nop 1
    v_permlane16_swap_b32 v76, v74
    v_add_f32 v76, v76, v74
    v_mov_b32 v74, v76
    s_nop 1
    v_permlane32_swap_b32 v76, v74
    v_add_f32 v76, v76, v74
    v_rcp_f32 v75, v75
    v_rcp_f32 v76, v76
    v_mul_f32 v40, v40, v75
    v_mul_f32 v78, v78, v76
    v_mul_f32 v41, v41, v75
    v_mul_f32 v79, v79, v76
    v_mul_f32 v42, v42, v75
    v_mul_f32 v80, v80, v76
    v_mul_f32 v43, v43, v75
    v_mul_f32 v81, v81, v76
    v_mul_f32 v44, v44, v75
    v_mul_f32 v82, v82, v76
    v_mul_f32 v45, v45, v75
    v_mul_f32 v83, v83, v76
    v_mul_f32 v46, v46, v75
    v_mul_f32 v84, v84, v76
    v_mul_f32 v47, v47, v75
    v_mul_f32 v85, v85, v76
    v_cvt_pk_bf16_f32 v56, v40, v41
    v_cvt_pk_bf16_f32 v60, v78, v79
    v_cvt_pk_bf16_f32 v57, v42, v43
    v_cvt_pk_bf16_f32 v61, v80, v81
    v_cvt_pk_bf16_f32 v58, v44, v45
    v_cvt_pk_bf16_f32 v62, v82, v83
    v_cvt_pk_bf16_f32 v59, v46, v47
    v_cvt_pk_bf16_f32 v63, v84, v85
    s_cmp_lg_u32 s64, 0
    s_cbranch_scc1 L_zp_14
    s_cmp_lg_u32 s5, 0
    s_cbranch_scc1 L_wd_16
    v_mov_b32 v8, s4
    s_lshl_b32 s10, s64, 3
    s_add_u32 s10, s10, 7
    s_lshl_b32 s10, s10, 12
    v_lshlrev_b32 v8, 7, v8
    v_lshl_add_u32 v8, v2, 3, v8
    v_add_u32 v8, s10, v8
    s_mov_b32 exec_lo, 0xffff
    s_mov_b32 exec_hi, 0x0
    s_mov_b32 s15, 0
    s_nop 5
L_poll_17:
    buffer_load_dwordx2 v[10:11], v8, s[92:95], 0 offen sc1
    s_waitcnt vmcnt(0)
    v_cmp_ne_u64 vcc, s[90:91], v[10:11]
    s_add_u32 s15, s15, 1
    s_cmp_gt_u32 s15, 0x40000
    s_cbranch_scc1 L_abort
    s_cmp_eq_u64 vcc, 0
    s_nop 2
    s_cbranch_scc1 L_poll_17_done
    s_sleep 1
    s_branch L_poll_17
L_poll_17_done:
    s_mov_b64 exec, -1
L_wd_16:
    s_barrier
    s_branch L_zq_15
L_zp_14:
    s_barrier
L_zq_15:
    s_lshl_b32 s10, s5, 4
    v_add_u32 v9, s10, v2
    v_lshlrev_b32 v10, 7, v9
    v_lshl_add_u32 v10, v3, 4, v10
    v_add_u32 v10, 0x0, v10
    ds_write_b128 v10, v[56:59]
    ds_write_b128 v10, v[60:63] offset:64
    v_lshlrev_b32 v10, 6, v9
    v_lshl_add_u32 v10, v3, 4, v10
    v_add_u32 v10, 0x4000, v10
    ds_write_b128 v10, v[64:67]
    s_waitcnt lgkmcnt(0)
    s_barrier
    v_lshl_add_u32 v8, v3, 3, v4
    s_and_b32 s10, s5, 1
    s_lshl_b32 s10, s10, 5
    s_add_u32 s10, s10, 0x4000
    v_lshlrev_b32 v9, 6, v8
    v_lshl_add_u32 v9, v5, 3, v9
    v_add_u32 v9, s10, v9
    s_lshr_b32 s10, s5, 1
    s_lshl_b32 s10, s10, 5
    s_add_u32 s10, s10, 0x0
    v_lshlrev_b32 v10, 7, v8
    v_lshl_add_u32 v10, v5, 3, v10
    v_add_u32 v10, s10, v10
    ds_read_b64_tr_b16 v[96:97], v9 offset:0
    ds_read_b64_tr_b16 v[112:113], v10 offset:0
    ds_read_b64_tr_b16 v[98:99], v9 offset:256
    ds_read_b64_tr_b16 v[114:115], v10 offset:512
    ds_read_b64_tr_b16 v[100:101], v9 offset:2048
    ds_read_b64_tr_b16 v[116:117], v10 offset:4096
    ds_read_b64_tr_b16 v[102:103], v9 offset:2304
    ds_read_b64_tr_b16 v[118:119], v10 offset:4608
    ds_read_b64_tr_b16 v[104:105], v9 offset:4096
    ds_read_b64_tr_b16 v[120:121], v10 offset:8192
    ds_read_b64_tr_b16 v[106:107], v9 offset:4352
    ds_read_b64_tr_b16 v[122:123], v10 offset:8704
    ds_read_b64_tr_b16 v[108:109], v9 offset:6144
    ds_read_b64_tr_b16 v[124:125], v10 offset:12288
    ds_read_b64_tr_b16 v[110:111], v9 offset:6400
    ds_read_b64_tr_b16 v[126:127], v10 offset:12800
    v_mov_b32 v128, 0
    v_mov_b32 v129, 0
    v_mov_b32 v130, 0
    v_mov_b32 v131, 0
    s_waitcnt lgkmcnt(0)
    s_nop 0
    v_mfma_f32_16x16x32_bf16 v[128:131], v[96:99], v[112:115], v[128:131]
    v_mfma_f32_16x16x32_bf16 v[128:131], v[100:103], v[116:119], v[128:131]
    v_mfma_f32_16x16x32_bf16 v[128:131], v[104:107], v[120:123], v[128:131]
    v_mfma_f32_16x16x32_bf16 v[128:131], v[108:111], v[124:127], v[128:131]
    s_lshl_b32 s10, s4, 13
    s_and_b32 s11, s5, 1
    s_lshl_b32 s11, s11, 12
    s_add_u32 s10, s10, s11
    s_lshr_b32 s11, s5, 1
    s_lshl_b32 s11, s11, 6
    s_add_u32 s10, s10, s11
    v_lshlrev_b32 v8, 10, v3
    v_lshl_add_u32 v8, v2, 2, v8
    v_add_u32 v8, s10, v8
    buffer_atomic_add_f32 v128, v8, s[52:55], 0 offen offset:0
    buffer_atomic_add_f32 v129, v8, s[52:55], 0 offen offset:256
    buffer_atomic_add_f32 v130, v8, s[52:55], 0 offen offset:512
    buffer_atomic_add_f32 v131, v8, s[52:55], 0 offen offset:768
    v_cndmask_b32 v36, v36, v32, s[60:61]
    v_cndmask_b32 v37, v37, v32, s[60:61]
    v_cndmask_b32 v38, v38, v32, s[60:61]
    v_cndmask_b32 v39, v39, v32, s[60:61]
    v_max3_f32 v72, v32, v33, v34
    v_max3_f32 v72, v72, v35, v36
    v_max3_f32 v72, v72, v37, v38
    v_max_f32 v72, v72, v39
    v_min3_f32 v73, v32, v33, v34
    v_min3_f32 v73, v73, v35, v36
    v_min3_f32 v73, v73, v37, v38
    v_min_f32 v73, v73, v39
    v_mov_b32 v74, v72
    s_nop 1
    v_permlane16_swap_b32 v72, v74
    v_max_f32 v72, v72, v74
    v_mov_b32 v74, v72
    s_nop 1
    v_permlane32_swap_b32 v72, v74
    v_max_f32 v72, v72, v74
    v_mov_b32 v74, v73
    s_nop 1
    v_permlane16_swap_b32 v73, v74
    v_min_f32 v73, v73, v74
    v_mov_b32 v74, v73
    s_nop 1
    v_permlane32_swap_b32 v73, v74
    v_min_f32 v73, v73, v74
    v_mov_b32 v74, 0x3fb8aa3b
    v_sub_f32 v78, v73, v32
    v_sub_f32 v32, v32, v72
    v_mul_f32 v78, v78, v74
    v_mul_f32 v32, v32, v74
    v_exp_f32 v78, v78
    v_exp_f32 v32, v32
    v_sub_f32 v79, v73, v33
    v_sub_f32 v33, v33, v72
    v_mul_f32 v79, v79, v74
    v_mul_f32 v33, v33, v74
    v_exp_f32 v79, v79
    v_exp_f32 v33, v33
    v_sub_f32 v80, v73, v34
    v_sub_f32 v34, v34, v72
    v_mul_f32 v80, v80, v74
    v_mul_f32 v34, v34, v74
    v_exp_f32 v80, v80
    v_exp_f32 v34, v34
    v_sub_f32 v81, v73, v35
    v_sub_f32 v35, v35, v72
    v_mul_f32 v81, v81, v74
    v_mul_f32 v35, v35, v74
    v_exp_f32 v81, v81
    v_exp_f32 v35, v35
    v_sub_f32 v82, v73, v36
    v_sub_f32 v36, v36, v72
    v_mul_f32 v82, v82, v74
    v_mul_f32 v36, v36, v74
    v_exp_f32 v82, v82
    v_exp_f32 v36, v36
    v_sub_f32 v83, v73, v37
    v_sub_f32 v37, v37, v72
    v_mul_f32 v83, v83, v74
    v_mul_f32 v37, v37, v74
    v_exp_f32 v83, v83
    v_exp_f32 v37, v37
    v_sub_f32 v84, v73, v38
    v_sub_f32 v38, v38, v72
    v_mul_f32 v84, v84, v74
    v_mul_f32 v38, v38, v74
    v_exp_f32 v84, v84
    v_exp_f32 v38, v38
    v_sub_f32 v85, v73, v39
    v_sub_f32 v39, v39, v72
    v_mul_f32 v85, v85, v74
    v_mul_f32 v39, v39, v74
    v_exp_f32 v85, v85
    v_exp_f32 v39, v39
    v_cndmask_b32 v36, v36, 0, s[60:61]
    v_cndmask_b32 v82, v82, 0, s[60:61]
    v_cndmask_b32 v37, v37, 0, s[60:61]
    v_cndmask_b32 v83, v83, 0, s[60:61]
    v_cndmask_b32 v38, v38, 0, s[60:61]
    v_cndmask_b32 v84, v84, 0, s[60:61]
    v_cndmask_b32 v39, v39, 0, s[60:61]
    v_cndmask_b32 v85, v85, 0, s[60:61]
    v_add_f32 v75, v32, v33
    v_add_f32 v76, v78, v79
    v_add_f32 v75, v75, v34
    v_add_f32 v76, v76, v80
    v_add_f32 v75, v75, v35
    v_add_f32 v76, v76, v81
    v_add_f32 v75, v75, v36
    v_add_f32 v76, v76, v82
    v_add_f32 v75, v75, v37
    v_add_f32 v76, v76, v83
    v_add_f32 v75, v75, v38
    v_add_f32 v76, v76, v84
    v_add_f32 v75, v75, v39
    v_add_f32 v76, v76, v85
    v_mov_b32 v74, v75
    s_nop 1
    v_permlane16_swap_b32 v75, v74
    v_add_f32 v75, v75, v74
    v_mov_b32 v74, v75
    s_nop 1
    v_permlane32_swap_b32 v75, v74
    v_add_f32 v75, v75, v74
    v_mov_b32 v74, v76
    s_nop 1
    v_permlane16_swap_b32 v76, v74
    v_add_f32 v76, v76, v74
    v_mov_b32 v74, v76
    s_nop 1
    v_permlane32_swap_b32 v76, v74
    v_add_f32 v76, v76, v74
    v_rcp_f32 v75, v75
    v_rcp_f32 v76, v76
    v_mul_f32 v32, v32, v75
    v_mul_f32 v78, v78, v76
    v_mul_f32 v33, v33, v75
    v_mul_f32 v79, v79, v76
    v_mul_f32 v34, v34, v75
    v_mul_f32 v80, v80, v76
    v_mul_f32 v35, v35, v75
    v_mul_f32 v81, v81, v76
    v_mul_f32 v36, v36, v75
    v_mul_f32 v82, v82, v76
    v_mul_f32 v37, v37, v75
    v_mul_f32 v83, v83, v76
    v_mul_f32 v38, v38, v75
    v_mul_f32 v84, v84, v76
    v_mul_f32 v39, v39, v75
    v_mul_f32 v85, v85, v76
    v_cvt_pk_bf16_f32 v248, v32, v33
    v_cvt_pk_bf16_f32 v252, v78, v79
    v_cvt_pk_bf16_f32 v249, v34, v35
    v_cvt_pk_bf16_f32 v253, v80, v81
    v_cvt_pk_bf16_f32 v250, v36, v37
    v_cvt_pk_bf16_f32 v254, v82, v83
    v_cvt_pk_bf16_f32 v251, v38, v39
    v_cvt_pk_bf16_f32 v255, v84, v85
    s_cmp_lg_u32 s5, 0
    s_cbranch_scc1 L_gt_18
    s_cmp_lg_u32 s90, 0
    s_cbranch_scc1 L_gt_18
    v_mov_b32 v8, 0
    s_mov_b32 s15, 0
    s_nop 3
L_gtp_19:
    buffer_load_dwordx2 v[10:11], v8, s[76:79], 0 offen sc1
    s_waitcnt vmcnt(0)
    v_readfirstlane_b32 s90, v10
    v_readfirstlane_b32 s91, v11
    s_add_u32 s15, s15, 1
    s_cmp_gt_u32 s15, 0x40000
    s_cbranch_scc1 L_abort
    s_cmp_lg_u32 s90, 0
    s_cbranch_scc1 L_gt_18
    s_sleep 2
    s_branch L_gtp_19
L_gt_18:
    s_waitcnt vmcnt(0) lgkmcnt(0)
    s_barrier
    s_cmp_lg_u32 s5, 0
    s_cbranch_scc1 L_sig_20
    v_mov_b32 v8, s4
    s_lshl_b32 s10, s64, 3
    s_add_u32 s10, s10, 0
    s_lshl_b32 s10, s10, 12
    s_lshl_b32 s11, s3, 3
    s_add_u32 s10, s10, s11
    v_lshlrev_b32 v8, 7, v8
    v_add_u32 v8, s10, v8
    v_mov_b32 v10, s90
    v_mov_b32 v11, s91
    s_mov_b64 exec, 1
    buffer_store_dwordx2 v[10:11], v8, s[92:95], 0 offen sc1
    s_mov_b64 exec, -1
L_sig_20:
    s_mov_b32 s40, s66
    s_mov_b32 s41, s67
    s_mov_b32 s42, 0x200000
    s_mov_b32 s43, 0x00020000
    s_add_u32 s52, s66, 0x600000
    s_addc_u32 s53, s67, 0
    s_mov_b32 s54, 0x1c0000
    s_mov_b32 s55, 0x00020000
    s_cmp_eq_u32 s74, 0
    s_cbranch_scc1 L_nopf_21
    s_mov_b32 s44, s22
    s_mov_b32 s45, s23
    s_mov_b32 s46, 0x62000
    s_mov_b32 s47, 0x00020000
    v_lshrrev_b32 v8, 3, v1
    s_lshl_b32 s10, s5, 3
    v_add_u32 v8, s10, v8
    s_mov_b32 s10, 896
    v_mul_lo_u32 v8, v8, s10
    v_bfe_u32 v9, v1, 4, 1
    s_and_b32 s10, s5, 1
    s_lshl_b32 s10, s10, 1
    v_or_b32 v9, s10, v9
    v_bfe_u32 v10, v1, 1, 2
    v_xor_b32 v9, v9, v10
    v_lshlrev_b32 v9, 5, v9
    v_and_b32 v10, 1, v1
    v_lshlrev_b32 v10, 4, v10
    v_add3_u32 v8, v8, v9, v10
    s_lshl_b32 s10, s7, 7
    s_add_u32 s10, s10, 0
    v_add_u32 v8, s10, v8
    s_lshl_b32 s12, s5, 10
    s_add_u32 s12, s12, 0
    s_add_u32 m0, s12, 0
    s_mov_b32 s10, 0
    buffer_load_dwordx4 v8, s[44:47], s10 offen lds
    s_add_u32 m0, s12, 8192
    s_mov_b32 s10, 57344
    buffer_load_dwordx4 v8, s[44:47], s10 offen lds
    s_add_u32 m0, s12, 16384
    s_mov_b32 s10, 114688
    buffer_load_dwordx4 v8, s[44:47], s10 offen lds
    s_add_u32 m0, s12, 24576
    s_mov_b32 s10, 172032
    buffer_load_dwordx4 v8, s[44:47], s10 offen lds
    s_add_u32 m0, s12, 32768
    s_mov_b32 s10, 229376
    buffer_load_dwordx4 v8, s[44:47], s10 offen lds
    s_add_u32 m0, s12, 40960
    s_mov_b32 s10, 286720
    buffer_load_dwordx4 v8, s[44:47], s10 offen lds
    s_add_u32 m0, s12, 49152
    s_mov_b32 s10, 344064
    buffer_load_dwordx4 v8, s[44:47], s10 offen lds
L_nopf_21:
    s_cmp_lg_u32 s5, 0
    s_cbranch_scc1 L_wd_22
    v_mov_b32 v8, s4
    s_lshl_b32 s10, s64, 3
    s_add_u32 s10, s10, 0
    s_lshl_b32 s10, s10, 12
    v_lshlrev_b32 v8, 7, v8
    v_lshl_add_u32 v8, v2, 3, v8
    v_add_u32 v8, s10, v8
    s_mov_b32 exec_lo, 0xffff
    s_mov_b32 exec_hi, 0x0
    s_mov_b32 s15, 0
    s_nop 5
L_poll_23:
    buffer_load_dwordx2 v[10:11], v8, s[92:95], 0 offen sc1
    s_waitcnt vmcnt(0)
    v_cmp_ne_u64 vcc, s[90:91], v[10:11]
    s_add_u32 s15, s15, 1
    s_cmp_gt_u32 s15, 0x40000
    s_cbranch_scc1 L_abort
    s_cmp_eq_u64 vcc, 0
    s_nop 2
    s_cbranch_scc1 L_poll_23_done
    s_sleep 1
    s_branch L_poll_23
L_poll_23_done:
    s_mov_b64 exec, -1
L_wd_22:
    s_barrier
    s_lshl_b32 s10, s4, 13
    v_lshlrev_b32 v8, 4, v0
    v_add_u32 v8, s10, v8
    buffer_load_dwordx4 v[72:75], v8, s[40:43], 0 offen
    s_waitcnt vmcnt(0)
    v_cvt_pk_bf16_f32 v76, v72, v73
    v_cvt_pk_bf16_f32 v77, v74, v75
    v_lshlrev_b32 v9, 3, v0
    v_add_u32 v9, 155648, v9
    ds_write_b64 v9, v[76:77]
    s_waitcnt lgkmcnt(0)
    s_barrier
    v_lshlrev_b32 v9, 7, v2
    v_lshl_add_u32 v9, v3, 4, v9
    v_add_u32 v9, 155648, v9
    ds_read_b128 v[24:27], v9 offset:0
    ds_read_b128 v[28:31], v9 offset:64
    ds_read_b128 v[32:35], v9 offset:2048
    ds_read_b128 v[36:39], v9 offset:2112
    v_mov_b32 v40, 0
    v_mov_b32 v41, 0
    v_mov_b32 v42, 0
    v_mov_b32 v43, 0
    v_mov_b32 v44, 0
    v_mov_b32 v45, 0
    v_mov_b32 v46, 0
    v_mov_b32 v47, 0
    s_waitcnt lgkmcnt(0)
    v_mfma_f32_16x16x32_bf16 v[40:43], v[24:27], v[248:251], v[40:43]
    v_mfma_f32_16x16x32_bf16 v[44:47], v[32:35], v[248:251], v[44:47]
    v_mfma_f32_16x16x32_bf16 v[40:43], v[28:31], v[252:255], v[40:43]
    v_mfma_f32_16x16x32_bf16 v[44:47], v[36:39], v[252:255], v[44:47]
    s_nop 7
    v_cndmask_b32 v48, 0, v44, s[60:61]
    v_mov_b32 v49, v48
    s_nop 1
    v_permlane16_swap_b32 v48, v49
    v_add_f32 v48, v48, v49
    v_mov_b32 v49, v48
    s_nop 1
    v_permlane32_swap_b32 v48, v49
    v_add_f32 v48, v48, v49
    v_add_f32 v48, 0x358637bd, v48
    v_rcp_f32 v48, v48
    s_nop 0
    v_mul_f32 v40, v40, v48
    v_mul_f32 v41, v41, v48
    v_mul_f32 v42, v42, v48
    v_mul_f32 v43, v43, v48
    v_mul_f32 v44, v44, v48
    v_mul_f32 v45, v45, v48
    v_mul_f32 v46, v46, v48
    v_mul_f32 v47, v47, v48
    v_cvt_pk_bf16_f32 v50, v40, v41
    v_cvt_pk_bf16_f32 v51, v42, v43
    v_cvt_pk_bf16_f32 v52, v44, v45
    v_cvt_pk_bf16_f32 v53, v46, v47
    s_mov_b32 s10, 896
    v_mul_lo_u32 v12, v7, s10
    s_mul_i32 s10, s4, 56
    v_and_b32 v13, 1, v3
    v_lshlrev_b32 v13, 5, v13
    v_lshrrev_b32 v14, 1, v3
    v_lshlrev_b32 v14, 3, v14
    v_add3_u32 v12, v12, v13, v14
    v_add_u32 v12, s10, v12
    buffer_store_dwordx2 v[50:51], v12, s[52:55], 0 offen sc1
    s_mov_b32 exec_hi, 0x0000ffff
    buffer_store_dwordx2 v[52:53], v12, s[52:55], 0 offen offset:16 sc1
    s_mov_b32 exec_hi, -1
    s_lshl_b32 s62, s3, 1
    s_add_u32 s63, s62, 1
    s_waitcnt vmcnt(0) lgkmcnt(0)
    s_barrier
    s_cmp_lg_u32 s5, 0
    s_cbranch_scc1 L_sig_24
    v_mov_b32 v8, s62
    v_mov_b32 v9, s63
    v_cmp_eq_u32 vcc, 1, v1
    s_nop 1
    v_cndmask_b32 v8, v8, v9, vcc
    s_lshl_b32 s10, s64, 3
    s_add_u32 s10, s10, 1
    s_lshl_b32 s10, s10, 12
    s_lshl_b32 s11, s4, 3
    s_add_u32 s10, s10, s11
    v_lshlrev_b32 v8, 7, v8
    v_add_u32 v8, s10, v8
    v_mov_b32 v10, s90
    v_mov_b32 v11, s91
    s_mov_b64 exec, 3
    buffer_store_dwordx2 v[10:11], v8, s[92:95], 0 offen sc1
    s_mov_b64 exec, -1
L_sig_24:
    s_cmp_eq_u32 s74, 0
    s_cbranch_scc1 L_warm_26
    s_lshl_b32 s8, s6, 6
    s_lshr_b32 s9, s5, 1
    s_lshl_b32 s9, s9, 4
    s_add_u32 s8, s8, s9
    v_add_u32 v7, s8, v2
    s_and_b32 s13, s5, 1
    s_add_u32 s44, s66, 0x600000
    s_addc_u32 s45, s67, 0
    s_mov_b32 s46, 0x1c0000
    s_mov_b32 s47, 0x00020000
    s_mov_b32 s48, s68
    s_mov_b32 s49, s69
    s_mov_b32 s50, 0x1c0000
    s_mov_b32 s51, 0x00020000
    s_add_u32 s52, s66, 0x800000
    s_addc_u32 s53, s67, 0
    s_mov_b32 s54, 0x1c0000
    s_mov_b32 s55, 0x00020000
    s_lshl_b32 s10, s6, 6
    s_lshl_b32 s11, s5, 3
    s_add_u32 s10, s10, s11
    s_mul_i32 s10, s10, 896
    s_and_b32 s11, s5, 1
    s_lshl_b32 s11, s11, 6
    v_xor_b32 v212, s11, v236
    v_add_u32 v212, s10, v212
    v_xor_b32 v213, s11, v237
    v_add_u32 v213, s10, v213
    v_xor_b32 v214, s11, v238
    v_add_u32 v214, s10, v214
    v_xor_b32 v215, s11, v239
    v_add_u32 v215, s10, v215
    v_xor_b32 v216, s11, v240
    v_add_u32 v216, s10, v216
    v_xor_b32 v217, s11, v241
    v_add_u32 v217, s10, v217
    v_xor_b32 v218, s11, v242
    v_add_u32 v218, s10, v218
    s_cmp_lg_u32 s5, 0
    s_cbranch_scc1 L_wd_27
    v_mov_b32 v8, s6
    s_lshl_b32 s10, s64, 3
    s_add_u32 s10, s10, 1
    s_lshl_b32 s10, s10, 12
    v_lshlrev_b32 v8, 7, v8
    v_lshl_add_u32 v8, v2, 3, v8
    v_add_u32 v8, s10, v8
    s_mov_b32 exec_lo, 0xffff
    s_mov_b32 exec_hi, 0x0
    s_mov_b32 s15, 0
    s_nop 5
L_poll_28:
    buffer_load_dwordx2 v[10:11], v8, s[92:95], 0 offen sc1
    s_waitcnt vmcnt(0)
    v_cmp_ne_u64 vcc, s[90:91], v[10:11]
    s_add_u32 s15, s15, 1
    s_cmp_gt_u32 s15, 0x40000
    s_cbranch_scc1 L_abort
    s_cmp_eq_u64 vcc, 0
    s_nop 2
    s_cbranch_scc1 L_poll_28_done
    s_sleep 1
    s_branch L_poll_28
L_poll_28_done:
    s_mov_b64 exec, -1
L_wd_27:
    s_barrier
    s_mul_i32 s12, s5, 7168
    s_add_u32 s12, s12, 57344
    s_add_u32 m0, s12, 0
    s_nop 0
    buffer_load_dwordx4 v212, s[44:47], 0 offen lds
    s_add_u32 m0, s12, 1024
    s_nop 0
    buffer_load_dwordx4 v213, s[44:47], 0 offen lds
    s_add_u32 m0, s12, 2048
    s_nop 0
    buffer_load_dwordx4 v214, s[44:47], 0 offen lds
    s_add_u32 m0, s12, 3072
    s_nop 0
    buffer_load_dwordx4 v215, s[44:47], 0 offen lds
    s_add_u32 m0, s12, 4096
    s_nop 0
    buffer_load_dwordx4 v216, s[44:47], 0 offen lds
    s_add_u32 m0, s12, 5120
    s_nop 0
    buffer_load_dwordx4 v217, s[44:47], 0 offen lds
    s_add_u32 m0, s12, 6144
    s_nop 0
    buffer_load_dwordx4 v218, s[44:47], 0 offen lds
    s_mov_b32 s10, 896
    v_mul_lo_u32 v13, v7, s10
    s_lshl_b32 s10, s7, 7
    s_lshl_b32 s11, s13, 6
    s_add_u32 s10, s10, s11
    v_lshlrev_b32 v14, 3, v3
    v_add3_u32 v13, v13, v14, s10
    buffer_load_dwordx2 v[112:113], v13, s[48:51], 0 offen
    buffer_load_dwordx2 v[114:115], v13, s[48:51], 0 offen offset:32
    v_lshl_add_u32 v120, v3, 3, v4
    v_lshlrev_b32 v120, 7, v120
    v_lshl_add_u32 v120, v5, 3, v120
    v_add_u32 v120, 0, v120
    v_lshrrev_b32 v122, 1, v4
    v_and_b32 v123, 1, v3
    v_lshl_or_b32 v122, v123, 1, v122
    s_lshl_b32 s10, s13, 1
    v_xor_b32 v123, s10, v122
    v_lshl_add_u32 v121, v123, 5, v120
    v_xor_b32 v123, 1, v123
    v_lshl_add_u32 v123, v123, 5, v120
    v_mov_b32 v120, v121
    v_mov_b32 v121, v123
    s_waitcnt vmcnt(0)
    s_barrier
    s_lshr_b32 s10, s5, 1
    s_mul_i32 s10, s10, 14336
    s_add_u32 s10, s10, 57344
    v_add_u32 v10, s10, v243
    v_add_u32 v11, s10, v244
    ds_read_b128 v[16:19], v10 offset:0
    ds_read_b128 v[20:23], v11 offset:0
    ds_read_b128 v[24:27], v10 offset:128
    ds_read_b128 v[28:31], v11 offset:128
    ds_read_b128 v[32:35], v10 offset:256
    ds_read_b128 v[36:39], v11 offset:256
    ds_read_b128 v[40:43], v10 offset:384
    ds_read_b128 v[44:47], v11 offset:384
    ds_read_b128 v[48:51], v10 offset:512
    ds_read_b128 v[52:55], v11 offset:512
    ds_read_b128 v[56:59], v10 offset:640
    ds_read_b128 v[60:63], v11 offset:640
    ds_read_b128 v[64:67], v10 offset:768
    ds_read_b128 v[68:71], v11 offset:768
    s_waitcnt lgkmcnt(0)
    s_barrier
    s_mov_b32 s40, s26
    s_mov_b32 s41, s27
    s_mov_b32 s42, 0x62000
    s_mov_b32 s43, 0x00020000
    v_lshrrev_b32 v8, 3, v1
    s_lshl_b32 s10, s5, 3
    v_add_u32 v8, s10, v8
    s_mov_b32 s10, 896
    v_mul_lo_u32 v8, v8, s10
    v_bfe_u32 v9, v1, 4, 1
    s_and_b32 s10, s5, 1
    s_lshl_b32 s10, s10, 1
    v_or_b32 v9, s10, v9
    v_bfe_u32 v10, v1, 1, 2
    v_xor_b32 v9, v9, v10
    v_lshlrev_b32 v9, 5, v9
    v_and_b32 v10, 1, v1
    v_lshlrev_b32 v10, 4, v10
    v_add3_u32 v8, v8, v9, v10
    s_lshl_b32 s10, s7, 7
    s_add_u32 s10, s10, 0
    v_add_u32 v8, s10, v8
    s_lshl_b32 s12, s5, 10
    s_add_u32 s12, s12, 57344
    s_add_u32 m0, s12, 0
    s_mov_b32 s10, 0
    buffer_load_dwordx4 v8, s[40:43], s10 offen lds
    s_add_u32 m0, s12, 8192
    s_mov_b32 s10, 57344
    buffer_load_dwordx4 v8, s[40:43], s10 offen lds
    s_add_u32 m0, s12, 16384
    s_mov_b32 s10, 114688
    buffer_load_dwordx4 v8, s[40:43], s10 offen lds
    s_add_u32 m0, s12, 24576
    s_mov_b32 s10, 172032
    buffer_load_dwordx4 v8, s[40:43], s10 offen lds
    s_add_u32 m0, s12, 32768
    s_mov_b32 s10, 229376
    buffer_load_dwordx4 v8, s[40:43], s10 offen lds
    s_add_u32 m0, s12, 40960
    s_mov_b32 s10, 286720
    buffer_load_dwordx4 v8, s[40:43], s10 offen lds
    s_add_u32 m0, s12, 49152
    s_mov_b32 s10, 344064
    buffer_load_dwordx4 v8, s[40:43], s10 offen lds
    v_mov_b32 v184, 0
    v_mov_b32 v185, 0
    v_mov_b32 v186, 0
    v_mov_b32 v187, 0
    v_mov_b32 v188, 0
    v_mov_b32 v189, 0
    v_mov_b32 v190, 0
    v_mov_b32 v191, 0
    ds_read_b64_tr_b16 v[128:129], v120 offset:0
    ds_read_b64_tr_b16 v[130:131], v120 offset:512
    ds_read_b64_tr_b16 v[132:133], v121 offset:0
    ds_read_b64_tr_b16 v[134:135], v121 offset:512
    ds_read_b64_tr_b16 v[136:137], v120 offset:4096
    ds_read_b64_tr_b16 v[138:139], v120 offset:4608
    ds_read_b64_tr_b16 v[140:141], v121 offset:4096
    ds_read_b64_tr_b16 v[142:143], v121 offset:4608
    ds_read_b64_tr_b16 v[144:145], v120 offset:8192
    ds_read_b64_tr_b16 v[146:147], v120 offset:8704
    ds_read_b64_tr_b16 v[148:149], v121 offset:8192
    ds_read_b64_tr_b16 v[150:151], v121 offset:8704
    s_waitcnt lgkmcnt(8)
    v_mfma_f32_16x16x32_bf16 v[184:187], v[128:131], v[16:19], v[184:187]
    v_mfma_f32_16x16x32_bf16 v[188:191], v[132:135], v[16:19], v[188:191]
    ds_read_b64_tr_b16 v[128:129], v120 offset:12288
    ds_read_b64_tr_b16 v[130:131], v120 offset:12800
    ds_read_b64_tr_b16 v[132:133], v121 offset:12288
    ds_read_b64_tr_b16 v[134:135], v121 offset:12800
    s_waitcnt lgkmcnt(8)
    v_mfma_f32_16x16x32_bf16 v[184:187], v[136:139], v[20:23], v[184:187]
    v_mfma_f32_16x16x32_bf16 v[188:191], v[140:143], v[20:23], v[188:191]
    ds_read_b64_tr_b16 v[136:137], v120 offset:16384
    ds_read_b64_tr_b16 v[138:139], v120 offset:16896
    ds_read_b64_tr_b16 v[140:141], v121 offset:16384
    ds_read_b64_tr_b16 v[142:143], v121 offset:16896
    s_waitcnt lgkmcnt(8)
    v_mfma_f32_16x16x32_bf16 v[184:187], v[144:147], v[24:27], v[184:187]
    v_mfma_f32_16x16x32_bf16 v[188:191], v[148:151], v[24:27], v[188:191]
    ds_read_b64_tr_b16 v[144:145], v120 offset:20480
    ds_read_b64_tr_b16 v[146:147], v120 offset:20992
    ds_read_b64_tr_b16 v[148:149], v121 offset:20480
    ds_read_b64_tr_b16 v[150:151], v121 offset:20992
    s_waitcnt lgkmcnt(8)
    v_mfma_f32_16x16x32_bf16 v[184:187], v[128:131], v[28:31], v[184:187]
    v_mfma_f32_16x16x32_bf16 v[188:191], v[132:135], v[28:31], v[188:191]
    ds_read_b64_tr_b16 v[128:129], v120 offset:24576
    ds_read_b64_tr_b16 v[130:131], v120 offset:25088
    ds_read_b64_tr_b16 v[132:133], v121 offset:24576
    ds_read_b64_tr_b16 v[134:135], v121 offset:25088
    s_waitcnt lgkmcnt(8)
    v_mfma_f32_16x16x32_bf16 v[184:187], v[136:139], v[32:35], v[184:187]
    v_mfma_f32_16x16x32_bf16 v[188:191], v[140:143], v[32:35], v[188:191]
    ds_read_b64_tr_b16 v[136:137], v120 offset:28672
    ds_read_b64_tr_b16 v[138:139], v120 offset:29184
    ds_read_b64_tr_b16 v[140:141], v121 offset:28672
    ds_read_b64_tr_b16 v[142:143], v121 offset:29184
    s_waitcnt lgkmcnt(8)
    v_mfma_f32_16x16x32_bf16 v[184:187], v[144:147], v[36:39], v[184:187]
    v_mfma_f32_16x16x32_bf16 v[188:191], v[148:151], v[36:39], v[188:191]
    ds_read_b64_tr_b16 v[144:145], v120 offset:32768
    ds_read_b64_tr_b16 v[146:147], v120 offset:33280
    ds_read_b64_tr_b16 v[148:149], v121 offset:32768
    ds_read_b64_tr_b16 v[150:151], v121 offset:33280
    s_waitcnt lgkmcnt(8)
    v_mfma_f32_16x16x32_bf16 v[184:187], v[128:131], v[40:43], v[184:187]
    v_mfma_f32_16x16x32_bf16 v[188:191], v[132:135], v[40:43], v[188:191]
    ds_read_b64_tr_b16 v[128:129], v120 offset:36864
    ds_read_b64_tr_b16 v[130:131], v120 offset:37376
    ds_read_b64_tr_b16 v[132:133], v121 offset:36864
    ds_read_b64_tr_b16 v[134:135], v121 offset:37376
    s_waitcnt lgkmcnt(8)
    v_mfma_f32_16x16x32_bf16 v[184:187], v[136:139], v[44:47], v[184:187]
    v_mfma_f32_16x16x32_bf16 v[188:191], v[140:143], v[44:47], v[188:191]
    ds_read_b64_tr_b16 v[136:137], v120 offset:40960
    ds_read_b64_tr_b16 v[138:139], v120 offset:41472
    ds_read_b64_tr_b16 v[140:141], v121 offset:40960
    ds_read_b64_tr_b16 v[142:143], v121 offset:41472
    s_waitcnt lgkmcnt(8)
    v_mfma_f32_16x16x32_bf16 v[184:187], v[144:147], v[48:51], v[184:187]
    v_mfma_f32_16x16x32_bf16 v[188:191], v[148:151], v[48:51], v[188:191]
    ds_read_b64_tr_b16 v[144:145], v120 offset:45056
    ds_read_b64_tr_b16 v[146:147], v120 offset:45568
    ds_read_b64_tr_b16 v[148:149], v121 offset:45056
    ds_read_b64_tr_b16 v[150:151], v121 offset:45568
    s_waitcnt lgkmcnt(8)
    v_mfma_f32_16x16x32_bf16 v[184:187], v[128:131], v[52:55], v[184:187]
    v_mfma_f32_16x16x32_bf16 v[188:191], v[132:135], v[52:55], v[188:191]
    ds_read_b64_tr_b16 v[128:129], v120 offset:49152
    ds_read_b64_tr_b16 v[130:131], v120 offset:49664
    ds_read_b64_tr_b16 v[132:133], v121 offset:49152
    ds_read_b64_tr_b16 v[134:135], v121 offset:49664
    s_waitcnt lgkmcnt(8)
    v_mfma_f32_16x16x32_bf16 v[184:187], v[136:139], v[56:59], v[184:187]
    v_mfma_f32_16x16x32_bf16 v[188:191], v[140:143], v[56:59], v[188:191]
    ds_read_b64_tr_b16 v[136:137], v120 offset:53248
    ds_read_b64_tr_b16 v[138:139], v120 offset:53760
    ds_read_b64_tr_b16 v[140:141], v121 offset:53248
    ds_read_b64_tr_b16 v[142:143], v121 offset:53760
    s_waitcnt lgkmcnt(8)
    v_mfma_f32_16x16x32_bf16 v[184:187], v[144:147], v[60:63], v[184:187]
    v_mfma_f32_16x16x32_bf16 v[188:191], v[148:151], v[60:63], v[188:191]
    s_waitcnt lgkmcnt(4)
    v_mfma_f32_16x16x32_bf16 v[184:187], v[128:131], v[64:67], v[184:187]
    v_mfma_f32_16x16x32_bf16 v[188:191], v[132:135], v[64:67], v[188:191]
    s_waitcnt lgkmcnt(0)
    v_mfma_f32_16x16x32_bf16 v[184:187], v[136:139], v[68:71], v[184:187]
    v_mfma_f32_16x16x32_bf16 v[188:191], v[140:143], v[68:71], v[188:191]
    v_lshlrev_b32 v212, 16, v112
    v_and_b32 v213, 0xffff0000, v112
    v_lshlrev_b32 v214, 16, v113
    v_and_b32 v215, 0xffff0000, v113
    v_lshlrev_b32 v216, 16, v114
    v_and_b32 v217, 0xffff0000, v114
    v_lshlrev_b32 v218, 16, v115
    v_and_b32 v219, 0xffff0000, v115
    v_add_f32 v184, v184, v212
    v_add_f32 v185, v185, v213
    v_add_f32 v186, v186, v214
    v_add_f32 v187, v187, v215
    v_add_f32 v188, v188, v216
    v_add_f32 v189, v189, v217
    v_add_f32 v190, v190, v218
    v_add_f32 v191, v191, v219
    v_cvt_pk_bf16_f32 v220, v184, v185
    v_cvt_pk_bf16_f32 v221, v186, v187
    v_cvt_pk_bf16_f32 v222, v188, v189
    v_cvt_pk_bf16_f32 v223, v190, v191
    v_lshlrev_b32 v14, 3, v3
    v_sub_u32 v14, v13, v14
    v_and_b32 v245, 1, v3
    v_lshl_add_u32 v14, v245, 5, v14
    v_lshrrev_b32 v245, 1, v3
    v_lshl_add_u32 v14, v245, 4, v14
    v_permlane16_swap_b32 v220, v222
    v_permlane16_swap_b32 v221, v223
    buffer_store_dwordx4 v[220:223], v14, s[52:55], 0 offen sc1
    s_waitcnt vmcnt(0) lgkmcnt(0)
    s_barrier
    s_cmp_lg_u32 s5, 0
    s_cbranch_scc1 L_sig_29
    v_mov_b32 v8, s6
    s_lshl_b32 s10, s64, 3
    s_add_u32 s10, s10, 2
    s_lshl_b32 s10, s10, 12
    s_lshl_b32 s11, s7, 3
    s_add_u32 s10, s10, s11
    v_lshlrev_b32 v8, 7, v8
    v_add_u32 v8, s10, v8
    v_mov_b32 v10, s90
    v_mov_b32 v11, s91
    s_mov_b64 exec, 1
    buffer_store_dwordx2 v[10:11], v8, s[92:95], 0 offen sc1
    s_mov_b64 exec, -1
L_sig_29:
    s_lshl_b32 s8, s6, 6
    s_lshr_b32 s9, s5, 1
    s_lshl_b32 s9, s9, 4
    s_add_u32 s8, s8, s9
    v_add_u32 v7, s8, v2
    s_and_b32 s13, s5, 1
    s_add_u32 s44, s66, 0x800000
    s_addc_u32 s45, s67, 0
    s_mov_b32 s46, 0x1c0000
    s_mov_b32 s47, 0x00020000
    s_add_u32 s52, s66, 0xa00000
    s_addc_u32 s53, s67, 0
    s_mov_b32 s54, 0x1c0000
    s_mov_b32 s55, 0x00020000
    s_add_u32 s56, s66, 0xe00000
    s_addc_u32 s57, s67, 0
    s_mov_b32 s58, 0x4000
    s_mov_b32 s59, 0x00020000
    s_lshl_b32 s10, s6, 6
    s_lshl_b32 s11, s5, 3
    s_add_u32 s10, s10, s11
    s_mul_i32 s10, s10, 896
    s_and_b32 s11, s5, 1
    s_lshl_b32 s11, s11, 6
    v_xor_b32 v212, s11, v236
    v_add_u32 v212, s10, v212
    v_xor_b32 v213, s11, v237
    v_add_u32 v213, s10, v213
    v_xor_b32 v214, s11, v238
    v_add_u32 v214, s10, v214
    v_xor_b32 v215, s11, v239
    v_add_u32 v215, s10, v215
    v_xor_b32 v216, s11, v240
    v_add_u32 v216, s10, v216
    v_xor_b32 v217, s11, v241
    v_add_u32 v217, s10, v217
    v_xor_b32 v218, s11, v242
    v_add_u32 v218, s10, v218
    s_waitcnt vmcnt(0)
    s_barrier
    s_sub_u32 s10, s5, 1
    s_cmp_ge_u32 s10, 4
    s_cbranch_scc1 L_cs_30
    v_lshl_add_u32 v8, v3, 3, v4
    v_mul_u32_u24 v8, 128, v8
    v_lshl_add_u32 v8, v5, 3, v8
    v_lshrrev_b32 v9, 1, v4
    v_and_b32 v10, 1, v3
    v_lshl_or_b32 v9, v10, 1, v9
    v_xor_b32 v9, s10, v9
    v_lshl_add_u32 v8, v9, 5, v8
    v_add_u32 v8, 57344, v8
    v_add_u32 v9, 61440, v8
    v_mov_b32 v12, 0
    v_mov_b32 v13, 0
    v_mov_b32 v14, 0
    v_mov_b32 v15, 0
    ds_read_b64_tr_b16 v[128:129], v8 offset:0
    ds_read_b64_tr_b16 v[130:131], v8 offset:512
    ds_read_b64_tr_b16 v[132:133], v8 offset:4096
    ds_read_b64_tr_b16 v[134:135], v8 offset:4608
    ds_read_b64_tr_b16 v[136:137], v8 offset:8192
    ds_read_b64_tr_b16 v[138:139], v8 offset:8704
    ds_read_b64_tr_b16 v[140:141], v8 offset:12288
    ds_read_b64_tr_b16 v[142:143], v8 offset:12800
    ds_read_b64_tr_b16 v[144:145], v8 offset:16384
    ds_read_b64_tr_b16 v[146:147], v8 offset:16896
    ds_read_b64_tr_b16 v[148:149], v8 offset:20480
    ds_read_b64_tr_b16 v[150:151], v8 offset:20992
    ds_read_b64_tr_b16 v[152:153], v8 offset:24576
    ds_read_b64_tr_b16 v[154:155], v8 offset:25088
    s_waitcnt lgkmcnt(0)
    v_mfma_f32_16x16x32_bf16 v[12:15], v[128:131], v[232:235], v[12:15]
    v_mfma_f32_16x16x32_bf16 v[12:15], v[132:135], v[232:235], v[12:15]
    v_mfma_f32_16x16x32_bf16 v[12:15], v[136:139], v[232:235], v[12:15]
    v_mfma_f32_16x16x32_bf16 v[12:15], v[140:143], v[232:235], v[12:15]
    v_mfma_f32_16x16x32_bf16 v[12:15], v[144:147], v[232:235], v[12:15]
    v_mfma_f32_16x16x32_bf16 v[12:15], v[148:151], v[232:235], v[12:15]
    v_mfma_f32_16x16x32_bf16 v[12:15], v[152:155], v[232:235], v[12:15]
    ds_read_b64_tr_b16 v[156:157], v8 offset:28672
    ds_read_b64_tr_b16 v[158:159], v8 offset:29184
    ds_read_b64_tr_b16 v[160:161], v8 offset:32768
    ds_read_b64_tr_b16 v[162:163], v8 offset:33280
    ds_read_b64_tr_b16 v[164:165], v8 offset:36864
    ds_read_b64_tr_b16 v[166:167], v8 offset:37376
    ds_read_b64_tr_b16 v[168:169], v8 offset:40960
    ds_read_b64_tr_b16 v[170:171], v8 offset:41472
    ds_read_b64_tr_b16 v[172:173], v8 offset:45056
    ds_read_b64_tr_b16 v[174:175], v8 offset:45568
    ds_read_b64_tr_b16 v[176:177], v8 offset:49152
    ds_read_b64_tr_b16 v[178:179], v8 offset:49664
    ds_read_b64_tr_b16 v[180:181], v8 offset:53248
    ds_read_b64_tr_b16 v[182:183], v8 offset:53760
    s_waitcnt lgkmcnt(0)
    v_mfma_f32_16x16x32_bf16 v[12:15], v[156:159], v[232:235], v[12:15]
    v_mfma_f32_16x16x32_bf16 v[12:15], v[160:163], v[232:235], v[12:15]
    v_mfma_f32_16x16x32_bf16 v[12:15], v[164:167], v[232:235], v[12:15]
    v_mfma_f32_16x16x32_bf16 v[12:15], v[168:171], v[232:235], v[12:15]
    v_mfma_f32_16x16x32_bf16 v[12:15], v[172:175], v[232:235], v[12:15]
    v_mfma_f32_16x16x32_bf16 v[12:15], v[176:179], v[232:235], v[12:15]
    v_mfma_f32_16x16x32_bf16 v[12:15], v[180:183], v[232:235], v[12:15]
    s_lshl_b32 s10, s10, 6
    v_lshlrev_b32 v8, 4, v3
    v_add_u32 v8, s10, v8
    v_add_u32 v8, 163328, v8
    s_mov_b32 exec_lo, 0x00010001
    s_mov_b32 exec_hi, 0x00010001
    s_nop 1
    ds_write_b128 v8, v[12:15]
    s_mov_b64 exec, -1
    s_waitcnt lgkmcnt(0)
L_cs_30:
    s_cmp_lg_u32 s5, 0
    s_cbranch_scc1 L_wd_31
    v_mov_b32 v8, s6
    s_lshl_b32 s10, s64, 3
    s_add_u32 s10, s10, 2
    s_lshl_b32 s10, s10, 12
    v_lshlrev_b32 v8, 7, v8
    v_lshl_add_u32 v8, v2, 3, v8
    v_add_u32 v8, s10, v8
    s_mov_b32 exec_lo, 0x7f
    s_mov_b32 exec_hi, 0x0
    s_mov_b32 s15, 0
    s_nop 5
L_poll_32:
    buffer_load_dwordx2 v[10:11], v8, s[92:95], 0 offen sc1
    s_waitcnt vmcnt(0)
    v_cmp_ne_u64 vcc, s[90:91], v[10:11]
    s_add_u32 s15, s15, 1
    s_cmp_gt_u32 s15, 0x40000
    s_cbranch_scc1 L_abort
    s_cmp_eq_u64 vcc, 0
    s_nop 2
    s_cbranch_scc1 L_poll_32_done
    s_sleep 1
    s_branch L_poll_32
L_poll_32_done:
    s_mov_b64 exec, -1
L_wd_31:
    s_barrier
    s_mul_i32 s12, s5, 7168
    s_add_u32 s12, s12, 0
    s_add_u32 m0, s12, 0
    s_nop 0
    buffer_load_dwordx4 v212, s[44:47], 0 offen lds
    s_add_u32 m0, s12, 1024
    s_nop 0
    buffer_load_dwordx4 v213, s[44:47], 0 offen lds
    s_add_u32 m0, s12, 2048
    s_nop 0
    buffer_load_dwordx4 v214, s[44:47], 0 offen lds
    s_add_u32 m0, s12, 3072
    s_nop 0
    buffer_load_dwordx4 v215, s[44:47], 0 offen lds
    s_add_u32 m0, s12, 4096
    s_nop 0
    buffer_load_dwordx4 v216, s[44:47], 0 offen lds
    s_add_u32 m0, s12, 5120
    s_nop 0
    buffer_load_dwordx4 v217, s[44:47], 0 offen lds
    s_add_u32 m0, s12, 6144
    s_nop 0
    buffer_load_dwordx4 v218, s[44:47], 0 offen lds
    s_mov_b32 s10, 896
    v_mul_lo_u32 v13, v7, s10
    s_lshl_b32 s10, s7, 7
    s_lshl_b32 s11, s13, 6
    s_add_u32 s10, s10, s11
    v_lshlrev_b32 v14, 3, v3
    v_add3_u32 v13, v13, v14, s10
    v_lshl_add_u32 v120, v3, 3, v4
    v_lshlrev_b32 v120, 7, v120
    v_lshl_add_u32 v120, v5, 3, v120
    v_add_u32 v120, 57344, v120
    v_lshrrev_b32 v122, 1, v4
    v_and_b32 v123, 1, v3
    v_lshl_or_b32 v122, v123, 1, v122
    s_lshl_b32 s10, s13, 1
    v_xor_b32 v123, s10, v122
    v_lshl_add_u32 v121, v123, 5, v120
    v_xor_b32 v123, 1, v123
    v_lshl_add_u32 v123, v123, 5, v120
    v_mov_b32 v120, v121
    v_mov_b32 v121, v123
    s_waitcnt vmcnt(0)
    s_barrier
    s_lshr_b32 s10, s5, 1
    s_mul_i32 s10, s10, 14336
    s_add_u32 s10, s10, 0
    v_add_u32 v10, s10, v243
    v_add_u32 v11, s10, v244
    ds_read_b128 v[16:19], v10 offset:0
    ds_read_b128 v[20:23], v11 offset:0
    ds_read_b128 v[24:27], v10 offset:128
    ds_read_b128 v[28:31], v11 offset:128
    ds_read_b128 v[32:35], v10 offset:256
    ds_read_b128 v[36:39], v11 offset:256
    ds_read_b128 v[40:43], v10 offset:384
    ds_read_b128 v[44:47], v11 offset:384
    ds_read_b128 v[48:51], v10 offset:512
    ds_read_b128 v[52:55], v11 offset:512
    ds_read_b128 v[56:59], v10 offset:640
    ds_read_b128 v[60:63], v11 offset:640
    ds_read_b128 v[64:67], v10 offset:768
    ds_read_b128 v[68:71], v11 offset:768
    s_waitcnt lgkmcnt(0)
    s_barrier
    s_mov_b32 s40, s28
    s_mov_b32 s41, s29
    s_mov_b32 s42, 0x62000
    s_mov_b32 s43, 0x00020000
    v_lshrrev_b32 v8, 3, v1
    s_lshl_b32 s10, s5, 3
    v_add_u32 v8, s10, v8
    s_mov_b32 s10, 896
    v_mul_lo_u32 v8, v8, s10
    v_bfe_u32 v9, v1, 4, 1
    s_and_b32 s10, s5, 1
    s_lshl_b32 s10, s10, 1
    v_or_b32 v9, s10, v9
    v_bfe_u32 v10, v1, 1, 2
    v_xor_b32 v9, v9, v10
    v_lshlrev_b32 v9, 5, v9
    v_and_b32 v10, 1, v1
    v_lshlrev_b32 v10, 4, v10
    v_add3_u32 v8, v8, v9, v10
    s_lshl_b32 s10, s7, 7
    s_add_u32 s10, s10, 0
    v_add_u32 v8, s10, v8
    s_lshl_b32 s12, s5, 10
    s_add_u32 s12, s12, 0
    s_add_u32 m0, s12, 0
    s_mov_b32 s10, 0
    buffer_load_dwordx4 v8, s[40:43], s10 offen lds
    s_add_u32 m0, s12, 8192
    s_mov_b32 s10, 57344
    buffer_load_dwordx4 v8, s[40:43], s10 offen lds
    s_add_u32 m0, s12, 16384
    s_mov_b32 s10, 114688
    buffer_load_dwordx4 v8, s[40:43], s10 offen lds
    s_add_u32 m0, s12, 24576
    s_mov_b32 s10, 172032
    buffer_load_dwordx4 v8, s[40:43], s10 offen lds
    s_add_u32 m0, s12, 32768
    s_mov_b32 s10, 229376
    buffer_load_dwordx4 v8, s[40:43], s10 offen lds
    s_add_u32 m0, s12, 40960
    s_mov_b32 s10, 286720
    buffer_load_dwordx4 v8, s[40:43], s10 offen lds
    s_add_u32 m0, s12, 49152
    s_mov_b32 s10, 344064
    buffer_load_dwordx4 v8, s[40:43], s10 offen lds
    v_mov_b32 v224, 0
    v_mov_b32 v225, 0
    v_mov_b32 v226, 0
    v_mov_b32 v227, 0
    v_dot2_f32_bf16 v224, v16, v232, v224
    v_dot2_f32_bf16 v226, v16, v16, v226
    v_dot2_f32_bf16 v225, v17, v232, v225
    v_dot2_f32_bf16 v227, v17, v17, v227
    v_dot2_f32_bf16 v224, v18, v232, v224
    v_dot2_f32_bf16 v226, v18, v18, v226
    v_dot2_f32_bf16 v225, v19, v232, v225
    v_dot2_f32_bf16 v227, v19, v19, v227
    v_dot2_f32_bf16 v224, v20, v232, v224
    v_dot2_f32_bf16 v226, v20, v20, v226
    v_dot2_f32_bf16 v225, v21, v232, v225
    v_dot2_f32_bf16 v227, v21, v21, v227
    v_dot2_f32_bf16 v224, v22, v232, v224
    v_dot2_f32_bf16 v226, v22, v22, v226
    v_dot2_f32_bf16 v225, v23, v232, v225
    v_dot2_f32_bf16 v227, v23, v23, v227
    v_dot2_f32_bf16 v224, v24, v232, v224
    v_dot2_f32_bf16 v226, v24, v24, v226
    v_dot2_f32_bf16 v225, v25, v232, v225
    v_dot2_f32_bf16 v227, v25, v25, v227
    v_dot2_f32_bf16 v224, v26, v232, v224
    v_dot2_f32_bf16 v226, v26, v26, v226
    v_dot2_f32_bf16 v225, v27, v232, v225
    v_dot2_f32_bf16 v227, v27, v27, v227
    v_dot2_f32_bf16 v224, v28, v232, v224
    v_dot2_f32_bf16 v226, v28, v28, v226
    v_dot2_f32_bf16 v225, v29, v232, v225
    v_dot2_f32_bf16 v227, v29, v29, v227
    v_dot2_f32_bf16 v224, v30, v232, v224
    v_dot2_f32_bf16 v226, v30, v30, v226
    v_dot2_f32_bf16 v225, v31, v232, v225
    v_dot2_f32_bf16 v227, v31, v31, v227
    v_dot2_f32_bf16 v224, v32, v232, v224
    v_dot2_f32_bf16 v226, v32, v32, v226
    v_dot2_f32_bf16 v225, v33, v232, v225
    v_dot2_f32_bf16 v227, v33, v33, v227
    v_dot2_f32_bf16 v224, v34, v232, v224
    v_dot2_f32_bf16 v226, v34, v34, v226
    v_dot2_f32_bf16 v225, v35, v232, v225
    v_dot2_f32_bf16 v227, v35, v35, v227
    v_dot2_f32_bf16 v224, v36, v232, v224
    v_dot2_f32_bf16 v226, v36, v36, v226
    v_dot2_f32_bf16 v225, v37, v232, v225
    v_dot2_f32_bf16 v227, v37, v37, v227
    v_dot2_f32_bf16 v224, v38, v232, v224
    v_dot2_f32_bf16 v226, v38, v38, v226
    v_dot2_f32_bf16 v225, v39, v232, v225
    v_dot2_f32_bf16 v227, v39, v39, v227
    v_dot2_f32_bf16 v224, v40, v232, v224
    v_dot2_f32_bf16 v226, v40, v40, v226
    v_dot2_f32_bf16 v225, v41, v232, v225
    v_dot2_f32_bf16 v227, v41, v41, v227
    v_dot2_f32_bf16 v224, v42, v232, v224
    v_dot2_f32_bf16 v226, v42, v42, v226
    v_dot2_f32_bf16 v225, v43, v232, v225
    v_dot2_f32_bf16 v227, v43, v43, v227
    v_dot2_f32_bf16 v224, v44, v232, v224
    v_dot2_f32_bf16 v226, v44, v44, v226
    v_dot2_f32_bf16 v225, v45, v232, v225
    v_dot2_f32_bf16 v227, v45, v45, v227
    v_dot2_f32_bf16 v224, v46, v232, v224
    v_dot2_f32_bf16 v226, v46, v46, v226
    v_dot2_f32_bf16 v225, v47, v232, v225
    v_dot2_f32_bf16 v227, v47, v47, v227
    v_dot2_f32_bf16 v224, v48, v232, v224
    v_dot2_f32_bf16 v226, v48, v48, v226
    v_dot2_f32_bf16 v225, v49, v232, v225
    v_dot2_f32_bf16 v227, v49, v49, v227
    v_dot2_f32_bf16 v224, v50, v232, v224
    v_dot2_f32_bf16 v226, v50, v50, v226
    v_dot2_f32_bf16 v225, v51, v232, v225
    v_dot2_f32_bf16 v227, v51, v51, v227
    v_dot2_f32_bf16 v224, v52, v232, v224
    v_dot2_f32_bf16 v226, v52, v52, v226
    v_dot2_f32_bf16 v225, v53, v232, v225
    v_dot2_f32_bf16 v227, v53, v53, v227
    v_dot2_f32_bf16 v224, v54, v232, v224
    v_dot2_f32_bf16 v226, v54, v54, v226
    v_dot2_f32_bf16 v225, v55, v232, v225
    v_dot2_f32_bf16 v227, v55, v55, v227
    v_dot2_f32_bf16 v224, v56, v232, v224
    v_dot2_f32_bf16 v226, v56, v56, v226
    v_dot2_f32_bf16 v225, v57, v232, v225
    v_dot2_f32_bf16 v227, v57, v57, v227
    v_dot2_f32_bf16 v224, v58, v232, v224
    v_dot2_f32_bf16 v226, v58, v58, v226
    v_dot2_f32_bf16 v225, v59, v232, v225
    v_dot2_f32_bf16 v227, v59, v59, v227
    v_dot2_f32_bf16 v224, v60, v232, v224
    v_dot2_f32_bf16 v226, v60, v60, v226
    v_dot2_f32_bf16 v225, v61, v232, v225
    v_dot2_f32_bf16 v227, v61, v61, v227
    v_dot2_f32_bf16 v224, v62, v232, v224
    v_dot2_f32_bf16 v226, v62, v62, v226
    v_dot2_f32_bf16 v225, v63, v232, v225
    v_dot2_f32_bf16 v227, v63, v63, v227
    v_dot2_f32_bf16 v224, v64, v232, v224
    v_dot2_f32_bf16 v226, v64, v64, v226
    v_dot2_f32_bf16 v225, v65, v232, v225
    v_dot2_f32_bf16 v227, v65, v65, v227
    v_dot2_f32_bf16 v224, v66, v232, v224
    v_dot2_f32_bf16 v226, v66, v66, v226
    v_dot2_f32_bf16 v225, v67, v232, v225
    v_dot2_f32_bf16 v227, v67, v67, v227
    v_dot2_f32_bf16 v224, v68, v232, v224
    v_dot2_f32_bf16 v226, v68, v68, v226
    v_dot2_f32_bf16 v225, v69, v232, v225
    v_dot2_f32_bf16 v227, v69, v69, v227
    v_dot2_f32_bf16 v224, v70, v232, v224
    v_dot2_f32_bf16 v226, v70, v70, v226
    v_dot2_f32_bf16 v225, v71, v232, v225
    v_dot2_f32_bf16 v227, v71, v71, v227
    s_nop 1
    v_add_f32 v224, v224, v225
    v_add_f32 v226, v226, v227
    v_mov_b32 v229, v224
    s_nop 1
    v_permlane16_swap_b32 v224, v229
    v_add_f32 v224, v224, v229
    v_mov_b32 v229, v224
    s_nop 1
    v_permlane32_swap_b32 v224, v229
    v_add_f32 v224, v224, v229
    v_mov_b32 v229, v226
    s_nop 1
    v_permlane16_swap_b32 v226, v229
    v_add_f32 v226, v226, v229
    v_mov_b32 v229, v226
    s_nop 1
    v_permlane32_swap_b32 v226, v229
    v_add_f32 v226, v226, v229
    v_mul_f32 v224, 0x3b124925, v224
    v_mul_f32 v226, 0x3b124925, v226
    v_fma_f32 v226, -v224, v224, v226
    v_max_f32 v226, 0, v226
    v_add_f32 v225, 0x3727c5ac, v226
    v_rsq_f32 v225, v225
    s_nop 0
    v_mul_f32 v227, v225, v225
    v_mul_f32 v227, v227, v226
    v_add_f32 v227, 0x3727c5ac, v227
    v_rsq_f32 v227, v227
    s_nop 0
    v_mul_f32 v226, v227, v225
    v_mul_f32 v227, v224, v226
    v_sub_f32 v227, 0, v227
    s_or_b32 s10, s7, s13
    s_cmp_lg_u32 s10, 0
    s_cbranch_scc1 L_nostat_33
    v_lshlrev_b32 v14, 3, v7
    s_mov_b64 exec, 0xffff
    buffer_store_dwordx2 v[224:225], v14, s[56:59], 0 offen sc1
    s_mov_b64 exec, -1
L_nostat_33:
    v_mov_b32 v184, 0
    v_mov_b32 v185, 0
    v_mov_b32 v186, 0
    v_mov_b32 v187, 0
    v_mov_b32 v188, 0
    v_mov_b32 v189, 0
    v_mov_b32 v190, 0
    v_mov_b32 v191, 0
    ds_read_b64_tr_b16 v[128:129], v120 offset:0
    ds_read_b64_tr_b16 v[130:131], v120 offset:512
    ds_read_b64_tr_b16 v[132:133], v121 offset:0
    ds_read_b64_tr_b16 v[134:135], v121 offset:512
    ds_read_b64_tr_b16 v[136:137], v120 offset:4096
    ds_read_b64_tr_b16 v[138:139], v120 offset:4608
    ds_read_b64_tr_b16 v[140:141], v121 offset:4096
    ds_read_b64_tr_b16 v[142:143], v121 offset:4608
    ds_read_b64_tr_b16 v[144:145], v120 offset:8192
    ds_read_b64_tr_b16 v[146:147], v120 offset:8704
    ds_read_b64_tr_b16 v[148:149], v121 offset:8192
    ds_read_b64_tr_b16 v[150:151], v121 offset:8704
    s_waitcnt lgkmcnt(8)
    v_mfma_f32_16x16x32_bf16 v[184:187], v[128:131], v[16:19], v[184:187]
    v_mfma_f32_16x16x32_bf16 v[188:191], v[132:135], v[16:19], v[188:191]
    ds_read_b64_tr_b16 v[128:129], v120 offset:12288
    ds_read_b64_tr_b16 v[130:131], v120 offset:12800
    ds_read_b64_tr_b16 v[132:133], v121 offset:12288
    ds_read_b64_tr_b16 v[134:135], v121 offset:12800
    s_waitcnt lgkmcnt(8)
    v_mfma_f32_16x16x32_bf16 v[184:187], v[136:139], v[20:23], v[184:187]
    v_mfma_f32_16x16x32_bf16 v[188:191], v[140:143], v[20:23], v[188:191]
    ds_read_b64_tr_b16 v[136:137], v120 offset:16384
    ds_read_b64_tr_b16 v[138:139], v120 offset:16896
    ds_read_b64_tr_b16 v[140:141], v121 offset:16384
    ds_read_b64_tr_b16 v[142:143], v121 offset:16896
    s_waitcnt lgkmcnt(8)
    v_mfma_f32_16x16x32_bf16 v[184:187], v[144:147], v[24:27], v[184:187]
    v_mfma_f32_16x16x32_bf16 v[188:191], v[148:151], v[24:27], v[188:191]
    ds_read_b64_tr_b16 v[144:145], v120 offset:20480
    ds_read_b64_tr_b16 v[146:147], v120 offset:20992
    ds_read_b64_tr_b16 v[148:149], v121 offset:20480
    ds_read_b64_tr_b16 v[150:151], v121 offset:20992
    s_waitcnt lgkmcnt(8)
    v_mfma_f32_16x16x32_bf16 v[184:187], v[128:131], v[28:31], v[184:187]
    v_mfma_f32_16x16x32_bf16 v[188:191], v[132:135], v[28:31], v[188:191]
    ds_read_b64_tr_b16 v[128:129], v120 offset:24576
    ds_read_b64_tr_b16 v[130:131], v120 offset:25088
    ds_read_b64_tr_b16 v[132:133], v121 offset:24576
    ds_read_b64_tr_b16 v[134:135], v121 offset:25088
    s_waitcnt lgkmcnt(8)
    v_mfma_f32_16x16x32_bf16 v[184:187], v[136:139], v[32:35], v[184:187]
    v_mfma_f32_16x16x32_bf16 v[188:191], v[140:143], v[32:35], v[188:191]
    ds_read_b64_tr_b16 v[136:137], v120 offset:28672
    ds_read_b64_tr_b16 v[138:139], v120 offset:29184
    ds_read_b64_tr_b16 v[140:141], v121 offset:28672
    ds_read_b64_tr_b16 v[142:143], v121 offset:29184
    s_waitcnt lgkmcnt(8)
    v_mfma_f32_16x16x32_bf16 v[184:187], v[144:147], v[36:39], v[184:187]
    v_mfma_f32_16x16x32_bf16 v[188:191], v[148:151], v[36:39], v[188:191]
    ds_read_b64_tr_b16 v[144:145], v120 offset:32768
    ds_read_b64_tr_b16 v[146:147], v120 offset:33280
    ds_read_b64_tr_b16 v[148:149], v121 offset:32768
    ds_read_b64_tr_b16 v[150:151], v121 offset:33280
    s_waitcnt lgkmcnt(8)
    v_mfma_f32_16x16x32_bf16 v[184:187], v[128:131], v[40:43], v[184:187]
    v_mfma_f32_16x16x32_bf16 v[188:191], v[132:135], v[40:43], v[188:191]
    ds_read_b64_tr_b16 v[128:129], v120 offset:36864
    ds_read_b64_tr_b16 v[130:131], v120 offset:37376
    ds_read_b64_tr_b16 v[132:133], v121 offset:36864
    ds_read_b64_tr_b16 v[134:135], v121 offset:37376
    s_waitcnt lgkmcnt(8)
    v_mfma_f32_16x16x32_bf16 v[184:187], v[136:139], v[44:47], v[184:187]
    v_mfma_f32_16x16x32_bf16 v[188:191], v[140:143], v[44:47], v[188:191]
    ds_read_b64_tr_b16 v[136:137], v120 offset:40960
    ds_read_b64_tr_b16 v[138:139], v120 offset:41472
    ds_read_b64_tr_b16 v[140:141], v121 offset:40960
    ds_read_b64_tr_b16 v[142:143], v121 offset:41472
    s_waitcnt lgkmcnt(8)
    v_mfma_f32_16x16x32_bf16 v[184:187], v[144:147], v[48:51], v[184:187]
    v_mfma_f32_16x16x32_bf16 v[188:191], v[148:151], v[48:51], v[188:191]
    ds_read_b64_tr_b16 v[144:145], v120 offset:45056
    ds_read_b64_tr_b16 v[146:147], v120 offset:45568
    ds_read_b64_tr_b16 v[148:149], v121 offset:45056
    ds_read_b64_tr_b16 v[150:151], v121 offset:45568
    s_waitcnt lgkmcnt(8)
    v_mfma_f32_16x16x32_bf16 v[184:187], v[128:131], v[52:55], v[184:187]
    v_mfma_f32_16x16x32_bf16 v[188:191], v[132:135], v[52:55], v[188:191]
    ds_read_b64_tr_b16 v[128:129], v120 offset:49152
    ds_read_b64_tr_b16 v[130:131], v120 offset:49664
    ds_read_b64_tr_b16 v[132:133], v121 offset:49152
    ds_read_b64_tr_b16 v[134:135], v121 offset:49664
    s_waitcnt lgkmcnt(8)
    v_mfma_f32_16x16x32_bf16 v[184:187], v[136:139], v[56:59], v[184:187]
    v_mfma_f32_16x16x32_bf16 v[188:191], v[140:143], v[56:59], v[188:191]
    ds_read_b64_tr_b16 v[136:137], v120 offset:53248
    ds_read_b64_tr_b16 v[138:139], v120 offset:53760
    ds_read_b64_tr_b16 v[140:141], v121 offset:53248
    ds_read_b64_tr_b16 v[142:143], v121 offset:53760
    s_waitcnt lgkmcnt(8)
    v_mfma_f32_16x16x32_bf16 v[184:187], v[144:147], v[60:63], v[184:187]
    v_mfma_f32_16x16x32_bf16 v[188:191], v[148:151], v[60:63], v[188:191]
    s_waitcnt lgkmcnt(4)
    v_mfma_f32_16x16x32_bf16 v[184:187], v[128:131], v[64:67], v[184:187]
    v_mfma_f32_16x16x32_bf16 v[188:191], v[132:135], v[64:67], v[188:191]
    s_waitcnt lgkmcnt(0)
    v_mfma_f32_16x16x32_bf16 v[184:187], v[136:139], v[68:71], v[184:187]
    v_mfma_f32_16x16x32_bf16 v[188:191], v[140:143], v[68:71], v[188:191]
    v_lshlrev_b32 v9, 4, v3
    s_lshl_b32 s10, s13, 7
    v_add_u32 v9, s10, v9
    v_add_u32 v9, 163328, v9
    ds_read_b128 v[100:103], v9 offset:0
    ds_read_b128 v[104:107], v9 offset:64
    s_waitcnt lgkmcnt(0)
    v_mul_f32 v184, v184, v226
    v_fmac_f32 v184, v100, v227
    v_mul_f32 v185, v185, v226
    v_fmac_f32 v185, v101, v227
    v_mul_f32 v186, v186, v226
    v_fmac_f32 v186, v102, v227
    v_mul_f32 v187, v187, v226
    v_fmac_f32 v187, v103, v227
    v_mul_f32 v188, v188, v226
    v_fmac_f32 v188, v104, v227
    v_mul_f32 v189, v189, v226
    v_fmac_f32 v189, v105, v227
    v_mul_f32 v190, v190, v226
    v_fmac_f32 v190, v106, v227
    v_mul_f32 v191, v191, v226
    v_fmac_f32 v191, v107, v227
    v_mul_f32 v212, v184, v184
    v_mov_b32 v213, 0xc0135761
    v_fmac_f32 v213, 0xbdd2d3e8, v212
    v_mul_f32 v212, v213, v184
    v_exp_f32 v212, v212
    s_nop 0
    v_add_f32 v212, 1.0, v212
    v_rcp_f32 v212, v212
    s_nop 0
    v_mul_f32 v184, v184, v212
    v_mul_f32 v214, v185, v185
    v_mov_b32 v215, 0xc0135761
    v_fmac_f32 v215, 0xbdd2d3e8, v214
    v_mul_f32 v214, v215, v185
    v_exp_f32 v214, v214
    s_nop 0
    v_add_f32 v214, 1.0, v214
    v_rcp_f32 v214, v214
    s_nop 0
    v_mul_f32 v185, v185, v214
    v_mul_f32 v216, v186, v186
    v_mov_b32 v217, 0xc0135761
    v_fmac_f32 v217, 0xbdd2d3e8, v216
    v_mul_f32 v216, v217, v186
    v_exp_f32 v216, v216
    s_nop 0
    v_add_f32 v216, 1.0, v216
    v_rcp_f32 v216, v216
    s_nop 0
    v_mul_f32 v186, v186, v216
    v_mul_f32 v218, v187, v187
    v_mov_b32 v219, 0xc0135761
    v_fmac_f32 v219, 0xbdd2d3e8, v218
    v_mul_f32 v218, v219, v187
    v_exp_f32 v218, v218
    s_nop 0
    v_add_f32 v218, 1.0, v218
    v_rcp_f32 v218, v218
    s_nop 0
    v_mul_f32 v187, v187, v218
    v_mul_f32 v212, v188, v188
    v_mov_b32 v213, 0xc0135761
    v_fmac_f32 v213, 0xbdd2d3e8, v212
    v_mul_f32 v212, v213, v188
    v_exp_f32 v212, v212
    s_nop 0
    v_add_f32 v212, 1.0, v212
    v_rcp_f32 v212, v212
    s_nop 0
    v_mul_f32 v188, v188, v212
    v_mul_f32 v214, v189, v189
    v_mov_b32 v215, 0xc0135761
    v_fmac_f32 v215, 0xbdd2d3e8, v214
    v_mul_f32 v214, v215, v189
    v_exp_f32 v214, v214
    s_nop 0
    v_add_f32 v214, 1.0, v214
    v_rcp_f32 v214, v214
    s_nop 0
    v_mul_f32 v189, v189, v214
    v_mul_f32 v216, v190, v190
    v_mov_b32 v217, 0xc0135761
    v_fmac_f32 v217, 0xbdd2d3e8, v216
    v_mul_f32 v216, v217, v190
    v_exp_f32 v216, v216
    s_nop 0
    v_add_f32 v216, 1.0, v216
    v_rcp_f32 v216, v216
    s_nop 0
    v_mul_f32 v190, v190, v216
    v_mul_f32 v218, v191, v191
    v_mov_b32 v219, 0xc0135761
    v_fmac_f32 v219, 0xbdd2d3e8, v218
    v_mul_f32 v218, v219, v191
    v_exp_f32 v218, v218
    s_nop 0
    v_add_f32 v218, 1.0, v218
    v_rcp_f32 v218, v218
    s_nop 0
    v_mul_f32 v191, v191, v218
    v_cvt_pk_bf16_f32 v220, v184, v185
    v_cvt_pk_bf16_f32 v221, v186, v187
    v_cvt_pk_bf16_f32 v222, v188, v189
    v_cvt_pk_bf16_f32 v223, v190, v191
    v_lshlrev_b32 v14, 3, v3
    v_sub_u32 v14, v13, v14
    v_and_b32 v245, 1, v3
    v_lshl_add_u32 v14, v245, 5, v14
    v_lshrrev_b32 v245, 1, v3
    v_lshl_add_u32 v14, v245, 4, v14
    v_permlane16_swap_b32 v220, v222
    v_permlane16_swap_b32 v221, v223
    buffer_store_dwordx4 v[220:223], v14, s[52:55], 0 offen sc1
    s_waitcnt vmcnt(0) lgkmcnt(0)
    s_barrier
    s_cmp_lg_u32 s5, 0
    s_cbranch_scc1 L_sig_34
    v_mov_b32 v8, s6
    s_lshl_b32 s10, s64, 3
    s_add_u32 s10, s10, 3
    s_lshl_b32 s10, s10, 12
    s_lshl_b32 s11, s7, 3
    s_add_u32 s10, s10, s11
    v_lshlrev_b32 v8, 7, v8
    v_add_u32 v8, s10, v8
    v_mov_b32 v10, s90
    v_mov_b32 v11, s91
    s_mov_b64 exec, 1
    buffer_store_dwordx2 v[10:11], v8, s[92:95], 0 offen sc1
    s_mov_b64 exec, -1
L_sig_34:
    s_lshl_b32 s8, s6, 6
    s_lshr_b32 s9, s5, 1
    s_lshl_b32 s9, s9, 4
    s_add_u32 s8, s8, s9
    v_add_u32 v7, s8, v2
    s_and_b32 s13, s5, 1
    s_add_u32 s44, s66, 0xa00000
    s_addc_u32 s45, s67, 0
    s_mov_b32 s46, 0x1c0000
    s_mov_b32 s47, 0x00020000
    s_add_u32 s48, s66, 0x800000
    s_addc_u32 s49, s67, 0
    s_mov_b32 s50, 0x1c0000
    s_mov_b32 s51, 0x00020000
    s_add_u32 s52, s66, 0xc00000
    s_addc_u32 s53, s67, 0
    s_mov_b32 s54, 0x1c0000
    s_mov_b32 s55, 0x00020000
    s_add_u32 s56, s66, 0xe00000
    s_addc_u32 s57, s67, 0
    s_mov_b32 s58, 0x4000
    s_mov_b32 s59, 0x00020000
    s_lshl_b32 s10, s6, 6
    s_lshl_b32 s11, s5, 3
    s_add_u32 s10, s10, s11
    s_mul_i32 s10, s10, 896
    s_and_b32 s11, s5, 1
    s_lshl_b32 s11, s11, 6
    v_xor_b32 v212, s11, v236
    v_lshrrev_b32 v223, 4, v212
    v_mul_u32_u24 v220, 293, v223
    v_lshrrev_b32 v220, 14, v220
    v_mul_u32_u24 v220, 56, v220
    v_sub_u32 v220, v223, v220
    v_mul_u32_u24 v220, 37, v220
    v_lshrrev_b32 v220, 9, v220
    v_lshrrev_b32 v221, 1, v220
    v_add_u32 v221, 1, v221
    v_mul_u32_u24 v221, 896, v221
    v_and_b32 v220, 1, v220
    v_cmp_eq_u32 vcc, 1, v220
    v_sub_u32 v222, 0, v221
    s_nop 0
    v_cndmask_b32 v221, v222, v221, vcc
    v_add_u32 v212, v212, v221
    v_add_u32 v212, s10, v212
    v_xor_b32 v213, s11, v237
    v_lshrrev_b32 v223, 4, v213
    v_mul_u32_u24 v220, 293, v223
    v_lshrrev_b32 v220, 14, v220
    v_mul_u32_u24 v220, 56, v220
    v_sub_u32 v220, v223, v220
    v_mul_u32_u24 v220, 37, v220
    v_lshrrev_b32 v220, 9, v220
    v_lshrrev_b32 v221, 1, v220
    v_add_u32 v221, 1, v221
    v_mul_u32_u24 v221, 896, v221
    v_and_b32 v220, 1, v220
    v_cmp_eq_u32 vcc, 1, v220
    v_sub_u32 v222, 0, v221
    s_nop 0
    v_cndmask_b32 v221, v222, v221, vcc
    v_add_u32 v213, v213, v221
    v_add_u32 v213, s10, v213
    v_xor_b32 v214, s11, v238
    v_lshrrev_b32 v223, 4, v214
    v_mul_u32_u24 v220, 293, v223
    v_lshrrev_b32 v220, 14, v220
    v_mul_u32_u24 v220, 56, v220
    v_sub_u32 v220, v223, v220
    v_mul_u32_u24 v220, 37, v220
    v_lshrrev_b32 v220, 9, v220
    v_lshrrev_b32 v221, 1, v220
    v_add_u32 v221, 1, v221
    v_mul_u32_u24 v221, 896, v221
    v_and_b32 v220, 1, v220
    v_cmp_eq_u32 vcc, 1, v220
    v_sub_u32 v222, 0, v221
    s_nop 0
    v_cndmask_b32 v221, v222, v221, vcc
    v_add_u32 v214, v214, v221
    v_add_u32 v214, s10, v214
    v_xor_b32 v215, s11, v239
    v_lshrrev_b32 v223, 4, v215
    v_mul_u32_u24 v220, 293, v223
    v_lshrrev_b32 v220, 14, v220
    v_mul_u32_u24 v220, 56, v220
    v_sub_u32 v220, v223, v220
    v_mul_u32_u24 v220, 37, v220
    v_lshrrev_b32 v220, 9, v220
    v_lshrrev_b32 v221, 1, v220
    v_add_u32 v221, 1, v221
    v_mul_u32_u24 v221, 896, v221
    v_and_b32 v220, 1, v220
    v_cmp_eq_u32 vcc, 1, v220
    v_sub_u32 v222, 0, v221
    s_nop 0
    v_cndmask_b32 v221, v222, v221, vcc
    v_add_u32 v215, v215, v221
    v_add_u32 v215, s10, v215
    v_xor_b32 v216, s11, v240
    v_lshrrev_b32 v223, 4, v216
    v_mul_u32_u24 v220, 293, v223
    v_lshrrev_b32 v220, 14, v220
    v_mul_u32_u24 v220, 56, v220
    v_sub_u32 v220, v223, v220
    v_mul_u32_u24 v220, 37, v220
    v_lshrrev_b32 v220, 9, v220
    v_lshrrev_b32 v221, 1, v220
    v_add_u32 v221, 1, v221
    v_mul_u32_u24 v221, 896, v221
    v_and_b32 v220, 1, v220
    v_cmp_eq_u32 vcc, 1, v220
    v_sub_u32 v222, 0, v221
    s_nop 0
    v_cndmask_b32 v221, v222, v221, vcc
    v_add_u32 v216, v216, v221
    v_add_u32 v216, s10, v216
    v_xor_b32 v217, s11, v241
    v_lshrrev_b32 v223, 4, v217
    v_mul_u32_u24 v220, 293, v223
    v_lshrrev_b32 v220, 14, v220
    v_mul_u32_u24 v220, 56, v220
    v_sub_u32 v220, v223, v220
    v_mul_u32_u24 v220, 37, v220
    v_lshrrev_b32 v220, 9, v220
    v_lshrrev_b32 v221, 1, v220
    v_add_u32 v221, 1, v221
    v_mul_u32_u24 v221, 896, v221
    v_and_b32 v220, 1, v220
    v_cmp_eq_u32 vcc, 1, v220
    v_sub_u32 v222, 0, v221
    s_nop 0
    v_cndmask_b32 v221, v222, v221, vcc
    v_add_u32 v217, v217, v221
    v_add_u32 v217, s10, v217
    v_xor_b32 v218, s11, v242
    v_lshrrev_b32 v223, 4, v218
    v_mul_u32_u24 v220, 293, v223
    v_lshrrev_b32 v220, 14, v220
    v_mul_u32_u24 v220, 56, v220
    v_sub_u32 v220, v223, v220
    v_mul_u32_u24 v220, 37, v220
    v_lshrrev_b32 v220, 9, v220
    v_lshrrev_b32 v221, 1, v220
    v_add_u32 v221, 1, v221
    v_mul_u32_u24 v221, 896, v221
    v_and_b32 v220, 1, v220
    v_cmp_eq_u32 vcc, 1, v220
    v_sub_u32 v222, 0, v221
    s_nop 0
    v_cndmask_b32 v221, v222, v221, vcc
    v_add_u32 v218, v218, v221
    v_add_u32 v218, s10, v218
    s_sub_u32 s62, s6, 1
    s_max_i32 s62, s62, 0
    s_add_u32 s63, s6, 1
    s_min_u32 s63, s63, 31
    s_cmp_lg_u32 s5, 0
    s_cbranch_scc1 L_wd_35
    v_mov_b32 v8, s6
    v_mov_b32 v9, s62
    v_cmp_eq_u32 vcc, 1, v3
    s_nop 1
    v_cndmask_b32 v8, v8, v9, vcc
    v_mov_b32 v9, s63
    v_cmp_eq_u32 vcc, 2, v3
    s_nop 1
    v_cndmask_b32 v8, v8, v9, vcc
    s_lshl_b32 s10, s64, 3
    s_add_u32 s10, s10, 3
    s_lshl_b32 s10, s10, 12
    v_lshlrev_b32 v8, 7, v8
    v_lshl_add_u32 v8, v2, 3, v8
    v_add_u32 v8, s10, v8
    s_mov_b32 exec_lo, 0x7f007f
    s_mov_b32 exec_hi, 0x7f
    s_mov_b32 s15, 0
    s_nop 5
L_poll_36:
    buffer_load_dwordx2 v[10:11], v8, s[92:95], 0 offen sc1
    s_waitcnt vmcnt(0)
    v_cmp_ne_u64 vcc, s[90:91], v[10:11]
    s_add_u32 s15, s15, 1
    s_cmp_gt_u32 s15, 0x40000
    s_cbranch_scc1 L_abort
    s_cmp_eq_u64 vcc, 0
    s_nop 2
    s_cbranch_scc1 L_poll_36_done
    s_sleep 1
    s_branch L_poll_36
L_poll_36_done:
    s_mov_b64 exec, -1
L_wd_35:
    s_barrier
    s_mul_i32 s12, s5, 7168
    s_add_u32 s12, s12, 57344
    s_add_u32 m0, s12, 0
    s_nop 0
    buffer_load_dwordx4 v212, s[44:47], 0 offen lds
    s_add_u32 m0, s12, 1024
    s_nop 0
    buffer_load_dwordx4 v213, s[44:47], 0 offen lds
    s_add_u32 m0, s12, 2048
    s_nop 0
    buffer_load_dwordx4 v214, s[44:47], 0 offen lds
    s_add_u32 m0, s12, 3072
    s_nop 0
    buffer_load_dwordx4 v215, s[44:47], 0 offen lds
    s_add_u32 m0, s12, 4096
    s_nop 0
    buffer_load_dwordx4 v216, s[44:47], 0 offen lds
    s_add_u32 m0, s12, 5120
    s_nop 0
    buffer_load_dwordx4 v217, s[44:47], 0 offen lds
    s_add_u32 m0, s12, 6144
    s_nop 0
    buffer_load_dwordx4 v218, s[44:47], 0 offen lds
    s_mov_b32 s10, 896
    v_mul_lo_u32 v13, v7, s10
    s_lshl_b32 s10, s7, 7
    s_lshl_b32 s11, s13, 6
    s_add_u32 s10, s10, s11
    v_lshlrev_b32 v14, 3, v3
    v_add3_u32 v13, v13, v14, s10
    buffer_load_dwordx2 v[112:113], v13, s[48:51], 0 offen
    buffer_load_dwordx2 v[114:115], v13, s[48:51], 0 offen offset:32
    v_lshlrev_b32 v14, 3, v7
    buffer_load_dwordx2 v[116:117], v14, s[56:59], 0 offen
    v_lshl_add_u32 v120, v3, 3, v4
    v_lshlrev_b32 v120, 7, v120
    v_lshl_add_u32 v120, v5, 3, v120
    v_add_u32 v120, 0, v120
    v_lshrrev_b32 v122, 1, v4
    v_and_b32 v123, 1, v3
    v_lshl_or_b32 v122, v123, 1, v122
    s_lshl_b32 s10, s13, 1
    v_xor_b32 v123, s10, v122
    v_lshl_add_u32 v121, v123, 5, v120
    v_xor_b32 v123, 1, v123
    v_lshl_add_u32 v123, v123, 5, v120
    v_mov_b32 v120, v121
    v_mov_b32 v121, v123
    s_waitcnt vmcnt(0)
    s_barrier
    s_lshr_b32 s10, s5, 1
    s_mul_i32 s10, s10, 14336
    s_add_u32 s10, s10, 57344
    v_add_u32 v10, s10, v243
    v_add_u32 v11, s10, v244
    ds_read_b128 v[16:19], v10 offset:0
    ds_read_b128 v[20:23], v11 offset:0
    ds_read_b128 v[24:27], v10 offset:128
    ds_read_b128 v[28:31], v11 offset:128
    ds_read_b128 v[32:35], v10 offset:256
    ds_read_b128 v[36:39], v11 offset:256
    ds_read_b128 v[40:43], v10 offset:384
    ds_read_b128 v[44:47], v11 offset:384
    ds_read_b128 v[48:51], v10 offset:512
    ds_read_b128 v[52:55], v11 offset:512
    ds_read_b128 v[56:59], v10 offset:640
    ds_read_b128 v[60:63], v11 offset:640
    ds_read_b128 v[64:67], v10 offset:768
    ds_read_b128 v[68:71], v11 offset:768
    s_waitcnt lgkmcnt(0)
    s_barrier
    s_mov_b32 s40, s30
    s_mov_b32 s41, s31
    s_mov_b32 s42, 0x188000
    s_mov_b32 s43, 0x00020000
    s_mul_i32 s11, s4, 224
    s_lshl_b32 s12, s5, 10
    s_add_u32 s12, s12, 57344
    s_lshl_b32 s10, s5, 6
    v_add_u32 v12, s10, v1
    v_add_u32 v8, 0, v12
    v_mul_u32_u24 v9, 9363, v8
    v_lshrrev_b32 v9, 17, v9
    v_mul_u32_u24 v10, 14, v9
    v_sub_u32 v8, v8, v10
    v_bfe_u32 v10, v9, 3, 1
    v_lshlrev_b32 v10, 2, v10
    v_xor_b32 v9, v9, v10
    s_mov_b32 s10, 3584
    v_mul_lo_u32 v9, v9, s10
    v_lshl_add_u32 v9, v8, 4, v9
    s_add_u32 m0, s12, 0
    s_nop 0
    buffer_load_dwordx4 v9, s[40:43], s11 offen lds
    v_add_u32 v8, 512, v12
    v_mul_u32_u24 v9, 9363, v8
    v_lshrrev_b32 v9, 17, v9
    v_mul_u32_u24 v10, 14, v9
    v_sub_u32 v8, v8, v10
    v_bfe_u32 v10, v9, 3, 1
    v_lshlrev_b32 v10, 2, v10
    v_xor_b32 v9, v9, v10
    s_mov_b32 s10, 3584
    v_mul_lo_u32 v9, v9, s10
    v_lshl_add_u32 v9, v8, 4, v9
    s_add_u32 m0, s12, 8192
    s_nop 0
    buffer_load_dwordx4 v9, s[40:43], s11 offen lds
    v_add_u32 v8, 1024, v12
    v_mul_u32_u24 v9, 9363, v8
    v_lshrrev_b32 v9, 17, v9
    v_mul_u32_u24 v10, 14, v9
    v_sub_u32 v8, v8, v10
    v_bfe_u32 v10, v9, 3, 1
    v_lshlrev_b32 v10, 2, v10
    v_xor_b32 v9, v9, v10
    s_mov_b32 s10, 3584
    v_mul_lo_u32 v9, v9, s10
    v_lshl_add_u32 v9, v8, 4, v9
    s_add_u32 m0, s12, 16384
    s_nop 0
    buffer_load_dwordx4 v9, s[40:43], s11 offen lds
    v_add_u32 v8, 1536, v12
    v_mul_u32_u24 v9, 9363, v8
    v_lshrrev_b32 v9, 17, v9
    v_mul_u32_u24 v10, 14, v9
    v_sub_u32 v8, v8, v10
    v_bfe_u32 v10, v9, 3, 1
    v_lshlrev_b32 v10, 2, v10
    v_xor_b32 v9, v9, v10
    s_mov_b32 s10, 3584
    v_mul_lo_u32 v9, v9, s10
    v_lshl_add_u32 v9, v8, 4, v9
    s_add_u32 m0, s12, 24576
    s_nop 0
    buffer_load_dwordx4 v9, s[40:43], s11 offen lds
    v_add_u32 v8, 2048, v12
    v_mul_u32_u24 v9, 9363, v8
    v_lshrrev_b32 v9, 17, v9
    v_mul_u32_u24 v10, 14, v9
    v_sub_u32 v8, v8, v10
    v_bfe_u32 v10, v9, 3, 1
    v_lshlrev_b32 v10, 2, v10
    v_xor_b32 v9, v9, v10
    s_mov_b32 s10, 3584
    v_mul_lo_u32 v9, v9, s10
    v_lshl_add_u32 v9, v8, 4, v9
    s_add_u32 m0, s12, 32768
    s_nop 0
    buffer_load_dwordx4 v9, s[40:43], s11 offen lds
    v_add_u32 v8, 2560, v12
    v_mul_u32_u24 v9, 9363, v8
    v_lshrrev_b32 v9, 17, v9
    v_mul_u32_u24 v10, 14, v9
    v_sub_u32 v8, v8, v10
    v_bfe_u32 v10, v9, 3, 1
    v_lshlrev_b32 v10, 2, v10
    v_xor_b32 v9, v9, v10
    s_mov_b32 s10, 3584
    v_mul_lo_u32 v9, v9, s10
    v_lshl_add_u32 v9, v8, 4, v9
    s_add_u32 m0, s12, 40960
    s_nop 0
    buffer_load_dwordx4 v9, s[40:43], s11 offen lds
    v_add_u32 v8, 3072, v12
    v_mul_u32_u24 v9, 9363, v8
    v_lshrrev_b32 v9, 17, v9
    v_mul_u32_u24 v10, 14, v9
    v_sub_u32 v8, v8, v10
    v_bfe_u32 v10, v9, 3, 1
    v_lshlrev_b32 v10, 2, v10
    v_xor_b32 v9, v9, v10
    s_mov_b32 s10, 3584
    v_mul_lo_u32 v9, v9, s10
    v_lshl_add_u32 v9, v8, 4, v9
    s_add_u32 m0, s12, 49152
    s_nop 0
    buffer_load_dwordx4 v9, s[40:43], s11 offen lds
    v_add_u32 v8, 3584, v12
    v_mul_u32_u24 v9, 9363, v8
    v_lshrrev_b32 v9, 17, v9
    v_mul_u32_u24 v10, 14, v9
    v_sub_u32 v8, v8, v10
    v_bfe_u32 v10, v9, 3, 1
    v_lshlrev_b32 v10, 2, v10
    v_xor_b32 v9, v9, v10
    s_mov_b32 s10, 3584
    v_mul_lo_u32 v9, v9, s10
    v_lshl_add_u32 v9, v8, 4, v9
    s_add_u32 m0, s12, 57344
    s_nop 0
    buffer_load_dwordx4 v9, s[40:43], s11 offen lds
    v_add_u32 v8, 4096, v12
    v_mul_u32_u24 v9, 9363, v8
    v_lshrrev_b32 v9, 17, v9
    v_mul_u32_u24 v10, 14, v9
    v_sub_u32 v8, v8, v10
    v_bfe_u32 v10, v9, 3, 1
    v_lshlrev_b32 v10, 2, v10
    v_xor_b32 v9, v9, v10
    s_mov_b32 s10, 3584
    v_mul_lo_u32 v9, v9, s10
    v_lshl_add_u32 v9, v8, 4, v9
    s_add_u32 m0, s12, 65536
    s_nop 0
    buffer_load_dwordx4 v9, s[40:43], s11 offen lds
    v_add_u32 v8, 4608, v12
    v_mul_u32_u24 v9, 9363, v8
    v_lshrrev_b32 v9, 17, v9
    v_mul_u32_u24 v10, 14, v9
    v_sub_u32 v8, v8, v10
    v_bfe_u32 v10, v9, 3, 1
    v_lshlrev_b32 v10, 2, v10
    v_xor_b32 v9, v9, v10
    s_mov_b32 s10, 3584
    v_mul_lo_u32 v9, v9, s10
    v_lshl_add_u32 v9, v8, 4, v9
    s_add_u32 m0, s12, 73728
    s_nop 0
    buffer_load_dwordx4 v9, s[40:43], s11 offen lds
    v_add_u32 v8, 5120, v12
    v_mul_u32_u24 v9, 9363, v8
    v_lshrrev_b32 v9, 17, v9
    v_mul_u32_u24 v10, 14, v9
    v_sub_u32 v8, v8, v10
    v_bfe_u32 v10, v9, 3, 1
    v_lshlrev_b32 v10, 2, v10
    v_xor_b32 v9, v9, v10
    s_mov_b32 s10, 3584
    v_mul_lo_u32 v9, v9, s10
    v_lshl_add_u32 v9, v8, 4, v9
    s_add_u32 m0, s12, 81920
    s_nop 0
    buffer_load_dwordx4 v9, s[40:43], s11 offen lds
    v_add_u32 v8, 5632, v12
    v_mul_u32_u24 v9, 9363, v8
    v_lshrrev_b32 v9, 17, v9
    v_mul_u32_u24 v10, 14, v9
    v_sub_u32 v8, v8, v10
    v_bfe_u32 v10, v9, 3, 1
    v_lshlrev_b32 v10, 2, v10
    v_xor_b32 v9, v9, v10
    s_mov_b32 s10, 3584
    v_mul_lo_u32 v9, v9, s10
    v_lshl_add_u32 v9, v8, 4, v9
    s_add_u32 m0, s12, 90112
    s_nop 0
    buffer_load_dwordx4 v9, s[40:43], s11 offen lds
    s_cmp_ge_u32 s5, 2
    s_cbranch_scc1 L_wdg_37
    v_add_u32 v8, 6144, v12
    v_mul_u32_u24 v9, 9363, v8
    v_lshrrev_b32 v9, 17, v9
    v_mul_u32_u24 v10, 14, v9
    v_sub_u32 v8, v8, v10
    v_bfe_u32 v10, v9, 3, 1
    v_lshlrev_b32 v10, 2, v10
    v_xor_b32 v9, v9, v10
    s_mov_b32 s10, 3584
    v_mul_lo_u32 v9, v9, s10
    v_lshl_add_u32 v9, v8, 4, v9
    s_add_u32 m0, s12, 98304
    s_nop 0
    buffer_load_dwordx4 v9, s[40:43], s11 offen lds
L_wdg_37:
    v_mov_b32 v184, 0
    v_mov_b32 v185, 0
    v_mov_b32 v186, 0
    v_mov_b32 v187, 0
    v_mov_b32 v188, 0
    v_mov_b32 v189, 0
    v_mov_b32 v190, 0
    v_mov_b32 v191, 0
    ds_read_b64_tr_b16 v[128:129], v120 offset:0
    ds_read_b64_tr_b16 v[130:131], v120 offset:512
    ds_read_b64_tr_b16 v[132:133], v121 offset:0
    ds_read_b64_tr_b16 v[134:135], v121 offset:512
    ds_read_b64_tr_b16 v[136:137], v120 offset:4096
    ds_read_b64_tr_b16 v[138:139], v120 offset:4608
    ds_read_b64_tr_b16 v[140:141], v121 offset:4096
    ds_read_b64_tr_b16 v[142:143], v121 offset:4608
    ds_read_b64_tr_b16 v[144:145], v120 offset:8192
    ds_read_b64_tr_b16 v[146:147], v120 offset:8704
    ds_read_b64_tr_b16 v[148:149], v121 offset:8192
    ds_read_b64_tr_b16 v[150:151], v121 offset:8704
    s_waitcnt lgkmcnt(8)
    v_mfma_f32_16x16x32_bf16 v[184:187], v[128:131], v[16:19], v[184:187]
    v_mfma_f32_16x16x32_bf16 v[188:191], v[132:135], v[16:19], v[188:191]
    ds_read_b64_tr_b16 v[128:129], v120 offset:12288
    ds_read_b64_tr_b16 v[130:131], v120 offset:12800
    ds_read_b64_tr_b16 v[132:133], v121 offset:12288
    ds_read_b64_tr_b16 v[134:135], v121 offset:12800
    s_waitcnt lgkmcnt(8)
    v_mfma_f32_16x16x32_bf16 v[184:187], v[136:139], v[20:23], v[184:187]
    v_mfma_f32_16x16x32_bf16 v[188:191], v[140:143], v[20:23], v[188:191]
    ds_read_b64_tr_b16 v[136:137], v120 offset:16384
    ds_read_b64_tr_b16 v[138:139], v120 offset:16896
    ds_read_b64_tr_b16 v[140:141], v121 offset:16384
    ds_read_b64_tr_b16 v[142:143], v121 offset:16896
    s_waitcnt lgkmcnt(8)
    v_mfma_f32_16x16x32_bf16 v[184:187], v[144:147], v[24:27], v[184:187]
    v_mfma_f32_16x16x32_bf16 v[188:191], v[148:151], v[24:27], v[188:191]
    ds_read_b64_tr_b16 v[144:145], v120 offset:20480
    ds_read_b64_tr_b16 v[146:147], v120 offset:20992
    ds_read_b64_tr_b16 v[148:149], v121 offset:20480
    ds_read_b64_tr_b16 v[150:151], v121 offset:20992
    s_waitcnt lgkmcnt(8)
    v_mfma_f32_16x16x32_bf16 v[184:187], v[128:131], v[28:31], v[184:187]
    v_mfma_f32_16x16x32_bf16 v[188:191], v[132:135], v[28:31], v[188:191]
    ds_read_b64_tr_b16 v[128:129], v120 offset:24576
    ds_read_b64_tr_b16 v[130:131], v120 offset:25088
    ds_read_b64_tr_b16 v[132:133], v121 offset:24576
    ds_read_b64_tr_b16 v[134:135], v121 offset:25088
    s_waitcnt lgkmcnt(8)
    v_mfma_f32_16x16x32_bf16 v[184:187], v[136:139], v[32:35], v[184:187]
    v_mfma_f32_16x16x32_bf16 v[188:191], v[140:143], v[32:35], v[188:191]
    ds_read_b64_tr_b16 v[136:137], v120 offset:28672
    ds_read_b64_tr_b16 v[138:139], v120 offset:29184
    ds_read_b64_tr_b16 v[140:141], v121 offset:28672
    ds_read_b64_tr_b16 v[142:143], v121 offset:29184
    s_waitcnt lgkmcnt(8)
    v_mfma_f32_16x16x32_bf16 v[184:187], v[144:147], v[36:39], v[184:187]
    v_mfma_f32_16x16x32_bf16 v[188:191], v[148:151], v[36:39], v[188:191]
    ds_read_b64_tr_b16 v[144:145], v120 offset:32768
    ds_read_b64_tr_b16 v[146:147], v120 offset:33280
    ds_read_b64_tr_b16 v[148:149], v121 offset:32768
    ds_read_b64_tr_b16 v[150:151], v121 offset:33280
    s_waitcnt lgkmcnt(8)
    v_mfma_f32_16x16x32_bf16 v[184:187], v[128:131], v[40:43], v[184:187]
    v_mfma_f32_16x16x32_bf16 v[188:191], v[132:135], v[40:43], v[188:191]
    ds_read_b64_tr_b16 v[128:129], v120 offset:36864
    ds_read_b64_tr_b16 v[130:131], v120 offset:37376
    ds_read_b64_tr_b16 v[132:133], v121 offset:36864
    ds_read_b64_tr_b16 v[134:135], v121 offset:37376
    s_waitcnt lgkmcnt(8)
    v_mfma_f32_16x16x32_bf16 v[184:187], v[136:139], v[44:47], v[184:187]
    v_mfma_f32_16x16x32_bf16 v[188:191], v[140:143], v[44:47], v[188:191]
    ds_read_b64_tr_b16 v[136:137], v120 offset:40960
    ds_read_b64_tr_b16 v[138:139], v120 offset:41472
    ds_read_b64_tr_b16 v[140:141], v121 offset:40960
    ds_read_b64_tr_b16 v[142:143], v121 offset:41472
    s_waitcnt lgkmcnt(8)
    v_mfma_f32_16x16x32_bf16 v[184:187], v[144:147], v[48:51], v[184:187]
    v_mfma_f32_16x16x32_bf16 v[188:191], v[148:151], v[48:51], v[188:191]
    ds_read_b64_tr_b16 v[144:145], v120 offset:45056
    ds_read_b64_tr_b16 v[146:147], v120 offset:45568
    ds_read_b64_tr_b16 v[148:149], v121 offset:45056
    ds_read_b64_tr_b16 v[150:151], v121 offset:45568
    s_waitcnt lgkmcnt(8)
    v_mfma_f32_16x16x32_bf16 v[184:187], v[128:131], v[52:55], v[184:187]
    v_mfma_f32_16x16x32_bf16 v[188:191], v[132:135], v[52:55], v[188:191]
    ds_read_b64_tr_b16 v[128:129], v120 offset:49152
    ds_read_b64_tr_b16 v[130:131], v120 offset:49664
    ds_read_b64_tr_b16 v[132:133], v121 offset:49152
    ds_read_b64_tr_b16 v[134:135], v121 offset:49664
    s_waitcnt lgkmcnt(8)
    v_mfma_f32_16x16x32_bf16 v[184:187], v[136:139], v[56:59], v[184:187]
    v_mfma_f32_16x16x32_bf16 v[188:191], v[140:143], v[56:59], v[188:191]
    ds_read_b64_tr_b16 v[136:137], v120 offset:53248
    ds_read_b64_tr_b16 v[138:139], v120 offset:53760
    ds_read_b64_tr_b16 v[140:141], v121 offset:53248
    ds_read_b64_tr_b16 v[142:143], v121 offset:53760
    s_waitcnt lgkmcnt(8)
    v_mfma_f32_16x16x32_bf16 v[184:187], v[144:147], v[60:63], v[184:187]
    v_mfma_f32_16x16x32_bf16 v[188:191], v[148:151], v[60:63], v[188:191]
    s_waitcnt lgkmcnt(4)
    v_mfma_f32_16x16x32_bf16 v[184:187], v[128:131], v[64:67], v[184:187]
    v_mfma_f32_16x16x32_bf16 v[188:191], v[132:135], v[64:67], v[188:191]
    s_waitcnt lgkmcnt(0)
    v_mfma_f32_16x16x32_bf16 v[184:187], v[136:139], v[68:71], v[184:187]
    v_mfma_f32_16x16x32_bf16 v[188:191], v[140:143], v[68:71], v[188:191]
    v_lshlrev_b32 v212, 16, v112
    v_and_b32 v213, 0xffff0000, v112
    v_lshlrev_b32 v214, 16, v113
    v_and_b32 v215, 0xffff0000, v113
    v_lshlrev_b32 v216, 16, v114
    v_and_b32 v217, 0xffff0000, v114
    v_lshlrev_b32 v218, 16, v115
    v_and_b32 v219, 0xffff0000, v115
    v_sub_f32 v212, v212, v116
    v_fmac_f32 v184, v212, v117
    v_sub_f32 v213, v213, v116
    v_fmac_f32 v185, v213, v117
    v_sub_f32 v214, v214, v116
    v_fmac_f32 v186, v214, v117
    v_sub_f32 v215, v215, v116
    v_fmac_f32 v187, v215, v117
    v_sub_f32 v216, v216, v116
    v_fmac_f32 v188, v216, v117
    v_sub_f32 v217, v217, v116
    v_fmac_f32 v189, v217, v117
    v_sub_f32 v218, v218, v116
    v_fmac_f32 v190, v218, v117
    v_sub_f32 v219, v219, v116
    v_fmac_f32 v191, v219, v117
    v_cvt_pk_bf16_f32 v220, v184, v185
    v_cvt_pk_bf16_f32 v221, v186, v187
    v_cvt_pk_bf16_f32 v222, v188, v189
    v_cvt_pk_bf16_f32 v223, v190, v191
    v_lshlrev_b32 v14, 3, v3
    v_sub_u32 v14, v13, v14
    v_and_b32 v245, 1, v3
    v_lshl_add_u32 v14, v245, 5, v14
    v_lshrrev_b32 v245, 1, v3
    v_lshl_add_u32 v14, v245, 4, v14
    v_permlane16_swap_b32 v220, v222
    v_permlane16_swap_b32 v221, v223
    buffer_store_dwordx4 v[220:223], v14, s[52:55], 0 offen sc1
    s_waitcnt vmcnt(0) lgkmcnt(0)
    s_barrier
    s_cmp_lg_u32 s5, 0
    s_cbranch_scc1 L_sig_38
    v_mov_b32 v8, s6
    s_lshl_b32 s10, s64, 3
    s_add_u32 s10, s10, 4
    s_lshl_b32 s10, s10, 12
    s_lshl_b32 s11, s7, 3
    s_add_u32 s10, s10, s11
    v_lshlrev_b32 v8, 7, v8
    v_add_u32 v8, s10, v8
    v_mov_b32 v10, s90
    v_mov_b32 v11, s91
    s_mov_b64 exec, 1
    buffer_store_dwordx2 v[10:11], v8, s[92:95], 0 offen sc1
    s_mov_b64 exec, -1
L_sig_38:
    s_branch L_skipB_25
L_warm_26:
    s_cmp_lg_u32 s64, 0
    s_cbranch_scc1 L_skipB_25
    s_lshr_b32 s10, s2, 3
    s_sub_u32 s10, s10, 28
    s_mul_i32 s10, s10, 401408
    v_lshlrev_b32 v8, 4, v0
    v_add_u32 v8, s10, v8
    s_mov_b32 s40, s32
    s_mov_b32 s41, s33
    s_mov_b32 s42, 0x188000
    s_mov_b32 s43, 0x00020000
    s_mov_b32 s10, 0
    buffer_load_dwordx4 v[16:19], v8, s[40:43], s10 offen
    s_mov_b32 s10, 8192
    buffer_load_dwordx4 v[20:23], v8, s[40:43], s10 offen
    s_mov_b32 s10, 16384
    buffer_load_dwordx4 v[24:27], v8, s[40:43], s10 offen
    s_mov_b32 s10, 24576
    buffer_load_dwordx4 v[28:31], v8, s[40:43], s10 offen
    s_mov_b32 s10, 32768
    buffer_load_dwordx4 v[32:35], v8, s[40:43], s10 offen
    s_mov_b32 s10, 40960
    buffer_load_dwordx4 v[36:39], v8, s[40:43], s10 offen
    s_mov_b32 s10, 49152
    buffer_load_dwordx4 v[40:43], v8, s[40:43], s10 offen
    s_mov_b32 s10, 57344
    buffer_load_dwordx4 v[44:47], v8, s[40:43], s10 offen
    s_mov_b32 s10, 65536
    buffer_load_dwordx4 v[48:51], v8, s[40:43], s10 offen
    s_mov_b32 s10, 73728
    buffer_load_dwordx4 v[52:55], v8, s[40:43], s10 offen
    s_mov_b32 s10, 81920
    buffer_load_dwordx4 v[56:59], v8, s[40:43], s10 offen
    s_mov_b32 s10, 90112
    buffer_load_dwordx4 v[60:63], v8, s[40:43], s10 offen
    s_mov_b32 s10, 98304
    buffer_load_dwordx4 v[64:67], v8, s[40:43], s10 offen
    s_mov_b32 s10, 106496
    buffer_load_dwordx4 v[68:71], v8, s[40:43], s10 offen
    s_mov_b32 s10, 114688
    buffer_load_dwordx4 v[72:75], v8, s[40:43], s10 offen
    s_mov_b32 s10, 122880
    buffer_load_dwordx4 v[76:79], v8, s[40:43], s10 offen
    s_waitcnt vmcnt(8)
    s_mov_b32 s10, 131072
    buffer_load_dwordx4 v[16:19], v8, s[40:43], s10 offen
    s_mov_b32 s10, 139264
    buffer_load_dwordx4 v[20:23], v8, s[40:43], s10 offen
    s_mov_b32 s10, 147456
    buffer_load_dwordx4 v[24:27], v8, s[40:43], s10 offen
    s_mov_b32 s10, 155648
    buffer_load_dwordx4 v[28:31], v8, s[40:43], s10 offen
    s_mov_b32 s10, 163840
    buffer_load_dwordx4 v[32:35], v8, s[40:43], s10 offen
    s_mov_b32 s10, 172032
    buffer_load_dwordx4 v[36:39], v8, s[40:43], s10 offen
    s_mov_b32 s10, 180224
    buffer_load_dwordx4 v[40:43], v8, s[40:43], s10 offen
    s_mov_b32 s10, 188416
    buffer_load_dwordx4 v[44:47], v8, s[40:43], s10 offen
    s_mov_b32 s10, 196608
    buffer_load_dwordx4 v[48:51], v8, s[40:43], s10 offen
    s_mov_b32 s10, 204800
    buffer_load_dwordx4 v[52:55], v8, s[40:43], s10 offen
    s_mov_b32 s10, 212992
    buffer_load_dwordx4 v[56:59], v8, s[40:43], s10 offen
    s_mov_b32 s10, 221184
    buffer_load_dwordx4 v[60:63], v8, s[40:43], s10 offen
    s_mov_b32 s10, 229376
    buffer_load_dwordx4 v[64:67], v8, s[40:43], s10 offen
    s_mov_b32 s10, 237568
    buffer_load_dwordx4 v[68:71], v8, s[40:43], s10 offen
    s_mov_b32 s10, 245760
    buffer_load_dwordx4 v[72:75], v8, s[40:43], s10 offen
    s_mov_b32 s10, 253952
    buffer_load_dwordx4 v[76:79], v8, s[40:43], s10 offen
    s_waitcnt vmcnt(8)
    s_mov_b32 s10, 262144
    buffer_load_dwordx4 v[16:19], v8, s[40:43], s10 offen
    s_mov_b32 s10, 270336
    buffer_load_dwordx4 v[20:23], v8, s[40:43], s10 offen
    s_mov_b32 s10, 278528
    buffer_load_dwordx4 v[24:27], v8, s[40:43], s10 offen
    s_mov_b32 s10, 286720
    buffer_load_dwordx4 v[28:31], v8, s[40:43], s10 offen
    s_mov_b32 s10, 294912
    buffer_load_dwordx4 v[32:35], v8, s[40:43], s10 offen
    s_mov_b32 s10, 303104
    buffer_load_dwordx4 v[36:39], v8, s[40:43], s10 offen
    s_mov_b32 s10, 311296
    buffer_load_dwordx4 v[40:43], v8, s[40:43], s10 offen
    s_mov_b32 s10, 319488
    buffer_load_dwordx4 v[44:47], v8, s[40:43], s10 offen
    s_mov_b32 s10, 327680
    buffer_load_dwordx4 v[48:51], v8, s[40:43], s10 offen
    s_mov_b32 s10, 335872
    buffer_load_dwordx4 v[52:55], v8, s[40:43], s10 offen
    s_mov_b32 s10, 344064
    buffer_load_dwordx4 v[56:59], v8, s[40:43], s10 offen
    s_mov_b32 s10, 352256
    buffer_load_dwordx4 v[60:63], v8, s[40:43], s10 offen
    s_mov_b32 s10, 360448
    buffer_load_dwordx4 v[64:67], v8, s[40:43], s10 offen
    s_mov_b32 s10, 368640
    buffer_load_dwordx4 v[68:71], v8, s[40:43], s10 offen
    s_mov_b32 s10, 376832
    buffer_load_dwordx4 v[72:75], v8, s[40:43], s10 offen
    s_mov_b32 s10, 385024
    buffer_load_dwordx4 v[76:79], v8, s[40:43], s10 offen
    s_waitcnt vmcnt(8)
    s_mov_b32 s10, 393216
    buffer_load_dwordx4 v[16:19], v8, s[40:43], s10 offen
    s_waitcnt vmcnt(0)
L_skipB_25:
    s_lshl_b32 s8, s3, 7
    s_lshl_b32 s9, s5, 4
    s_add_u32 s8, s8, s9
    v_add_u32 v7, s8, v2
    s_mov_b32 s40, s30
    s_mov_b32 s41, s31
    s_mov_b32 s42, 0x188000
    s_mov_b32 s43, 0x00020000
    s_add_u32 s44, s66, 0xc00000
    s_addc_u32 s45, s67, 0
    s_mov_b32 s46, 0x1c0000
    s_mov_b32 s47, 0x00020000
    s_add_u32 s52, s66, 0x1000000
    s_addc_u32 s53, s67, 0
    s_mov_b32 s54, 0x700000
    s_mov_b32 s55, 0x00020000
    s_cmp_lg_u32 s74, 0
    s_cbranch_scc1 L_s5pf_39
    s_mul_i32 s11, s4, 224
    s_lshl_b32 s12, s5, 10
    s_add_u32 s12, s12, 57344
    s_lshl_b32 s10, s5, 6
    v_add_u32 v12, s10, v1
    v_add_u32 v8, 0, v12
    v_mul_u32_u24 v9, 9363, v8
    v_lshrrev_b32 v9, 17, v9
    v_mul_u32_u24 v10, 14, v9
    v_sub_u32 v8, v8, v10
    v_bfe_u32 v10, v9, 3, 1
    v_lshlrev_b32 v10, 2, v10
    v_xor_b32 v9, v9, v10
    s_mov_b32 s10, 3584
    v_mul_lo_u32 v9, v9, s10
    v_lshl_add_u32 v9, v8, 4, v9
    s_add_u32 m0, s12, 0
    s_nop 0
    buffer_load_dwordx4 v9, s[40:43], s11 offen lds
    v_add_u32 v8, 512, v12
    v_mul_u32_u24 v9, 9363, v8
    v_lshrrev_b32 v9, 17, v9
    v_mul_u32_u24 v10, 14, v9
    v_sub_u32 v8, v8, v10
    v_bfe_u32 v10, v9, 3, 1
    v_lshlrev_b32 v10, 2, v10
    v_xor_b32 v9, v9, v10
    s_mov_b32 s10, 3584
    v_mul_lo_u32 v9, v9, s10
    v_lshl_add_u32 v9, v8, 4, v9
    s_add_u32 m0, s12, 8192
    s_nop 0
    buffer_load_dwordx4 v9, s[40:43], s11 offen lds
    v_add_u32 v8, 1024, v12
    v_mul_u32_u24 v9, 9363, v8
    v_lshrrev_b32 v9, 17, v9
    v_mul_u32_u24 v10, 14, v9
    v_sub_u32 v8, v8, v10
    v_bfe_u32 v10, v9, 3, 1
    v_lshlrev_b32 v10, 2, v10
    v_xor_b32 v9, v9, v10
    s_mov_b32 s10, 3584
    v_mul_lo_u32 v9, v9, s10
    v_lshl_add_u32 v9, v8, 4, v9
    s_add_u32 m0, s12, 16384
    s_nop 0
    buffer_load_dwordx4 v9, s[40:43], s11 offen lds
    v_add_u32 v8, 1536, v12
    v_mul_u32_u24 v9, 9363, v8
    v_lshrrev_b32 v9, 17, v9
    v_mul_u32_u24 v10, 14, v9
    v_sub_u32 v8, v8, v10
    v_bfe_u32 v10, v9, 3, 1
    v_lshlrev_b32 v10, 2, v10
    v_xor_b32 v9, v9, v10
    s_mov_b32 s10, 3584
    v_mul_lo_u32 v9, v9, s10
    v_lshl_add_u32 v9, v8, 4, v9
    s_add_u32 m0, s12, 24576
    s_nop 0
    buffer_load_dwordx4 v9, s[40:43], s11 offen lds
    v_add_u32 v8, 2048, v12
    v_mul_u32_u24 v9, 9363, v8
    v_lshrrev_b32 v9, 17, v9
    v_mul_u32_u24 v10, 14, v9
    v_sub_u32 v8, v8, v10
    v_bfe_u32 v10, v9, 3, 1
    v_lshlrev_b32 v10, 2, v10
    v_xor_b32 v9, v9, v10
    s_mov_b32 s10, 3584
    v_mul_lo_u32 v9, v9, s10
    v_lshl_add_u32 v9, v8, 4, v9
    s_add_u32 m0, s12, 32768
    s_nop 0
    buffer_load_dwordx4 v9, s[40:43], s11 offen lds
    v_add_u32 v8, 2560, v12
    v_mul_u32_u24 v9, 9363, v8
    v_lshrrev_b32 v9, 17, v9
    v_mul_u32_u24 v10, 14, v9
    v_sub_u32 v8, v8, v10
    v_bfe_u32 v10, v9, 3, 1
    v_lshlrev_b32 v10, 2, v10
    v_xor_b32 v9, v9, v10
    s_mov_b32 s10, 3584
    v_mul_lo_u32 v9, v9, s10
    v_lshl_add_u32 v9, v8, 4, v9
    s_add_u32 m0, s12, 40960
    s_nop 0
    buffer_load_dwordx4 v9, s[40:43], s11 offen lds
    v_add_u32 v8, 3072, v12
    v_mul_u32_u24 v9, 9363, v8
    v_lshrrev_b32 v9, 17, v9
    v_mul_u32_u24 v10, 14, v9
    v_sub_u32 v8, v8, v10
    v_bfe_u32 v10, v9, 3, 1
    v_lshlrev_b32 v10, 2, v10
    v_xor_b32 v9, v9, v10
    s_mov_b32 s10, 3584
    v_mul_lo_u32 v9, v9, s10
    v_lshl_add_u32 v9, v8, 4, v9
    s_add_u32 m0, s12, 49152
    s_nop 0
    buffer_load_dwordx4 v9, s[40:43], s11 offen lds
    v_add_u32 v8, 3584, v12
    v_mul_u32_u24 v9, 9363, v8
    v_lshrrev_b32 v9, 17, v9
    v_mul_u32_u24 v10, 14, v9
    v_sub_u32 v8, v8, v10
    v_bfe_u32 v10, v9, 3, 1
    v_lshlrev_b32 v10, 2, v10
    v_xor_b32 v9, v9, v10
    s_mov_b32 s10, 3584
    v_mul_lo_u32 v9, v9, s10
    v_lshl_add_u32 v9, v8, 4, v9
    s_add_u32 m0, s12, 57344
    s_nop 0
    buffer_load_dwordx4 v9, s[40:43], s11 offen lds
    v_add_u32 v8, 4096, v12
    v_mul_u32_u24 v9, 9363, v8
    v_lshrrev_b32 v9, 17, v9
    v_mul_u32_u24 v10, 14, v9
    v_sub_u32 v8, v8, v10
    v_bfe_u32 v10, v9, 3, 1
    v_lshlrev_b32 v10, 2, v10
    v_xor_b32 v9, v9, v10
    s_mov_b32 s10, 3584
    v_mul_lo_u32 v9, v9, s10
    v_lshl_add_u32 v9, v8, 4, v9
    s_add_u32 m0, s12, 65536
    s_nop 0
    buffer_load_dwordx4 v9, s[40:43], s11 offen lds
    v_add_u32 v8, 4608, v12
    v_mul_u32_u24 v9, 9363, v8
    v_lshrrev_b32 v9, 17, v9
    v_mul_u32_u24 v10, 14, v9
    v_sub_u32 v8, v8, v10
    v_bfe_u32 v10, v9, 3, 1
    v_lshlrev_b32 v10, 2, v10
    v_xor_b32 v9, v9, v10
    s_mov_b32 s10, 3584
    v_mul_lo_u32 v9, v9, s10
    v_lshl_add_u32 v9, v8, 4, v9
    s_add_u32 m0, s12, 73728
    s_nop 0
    buffer_load_dwordx4 v9, s[40:43], s11 offen lds
    v_add_u32 v8, 5120, v12
    v_mul_u32_u24 v9, 9363, v8
    v_lshrrev_b32 v9, 17, v9
    v_mul_u32_u24 v10, 14, v9
    v_sub_u32 v8, v8, v10
    v_bfe_u32 v10, v9, 3, 1
    v_lshlrev_b32 v10, 2, v10
    v_xor_b32 v9, v9, v10
    s_mov_b32 s10, 3584
    v_mul_lo_u32 v9, v9, s10
    v_lshl_add_u32 v9, v8, 4, v9
    s_add_u32 m0, s12, 81920
    s_nop 0
    buffer_load_dwordx4 v9, s[40:43], s11 offen lds
    v_add_u32 v8, 5632, v12
    v_mul_u32_u24 v9, 9363, v8
    v_lshrrev_b32 v9, 17, v9
    v_mul_u32_u24 v10, 14, v9
    v_sub_u32 v8, v8, v10
    v_bfe_u32 v10, v9, 3, 1
    v_lshlrev_b32 v10, 2, v10
    v_xor_b32 v9, v9, v10
    s_mov_b32 s10, 3584
    v_mul_lo_u32 v9, v9, s10
    v_lshl_add_u32 v9, v8, 4, v9
    s_add_u32 m0, s12, 90112
    s_nop 0
    buffer_load_dwordx4 v9, s[40:43], s11 offen lds
    s_cmp_ge_u32 s5, 2
    s_cbranch_scc1 L_wdg_40
    v_add_u32 v8, 6144, v12
    v_mul_u32_u24 v9, 9363, v8
    v_lshrrev_b32 v9, 17, v9
    v_mul_u32_u24 v10, 14, v9
    v_sub_u32 v8, v8, v10
    v_bfe_u32 v10, v9, 3, 1
    v_lshlrev_b32 v10, 2, v10
    v_xor_b32 v9, v9, v10
    s_mov_b32 s10, 3584
    v_mul_lo_u32 v9, v9, s10
    v_lshl_add_u32 v9, v8, 4, v9
    s_add_u32 m0, s12, 98304
    s_nop 0
    buffer_load_dwordx4 v9, s[40:43], s11 offen lds
L_wdg_40:
L_s5pf_39:
    s_waitcnt vmcnt(0)
    s_barrier
    s_sub_u32 s10, s5, 1
    s_cmp_ge_u32 s10, 7
    s_cbranch_scc1 L_cs_41
    v_lshl_add_u32 v8, v3, 3, v4
    v_mul_u32_u24 v8, 224, v8
    v_lshl_add_u32 v8, v5, 3, v8
    v_and_b32 v9, 1, v3
    v_mul_u32_u24 v10, 896, v9
    s_lshl_b32 s11, s10, 5
    v_add_u32 v8, s11, v8
    v_add_u32 v8, 57344, v8
    v_sub_u32 v11, v8, v10
    v_add_u32 v11, 896, v11
    v_add_u32 v8, v8, v10
    v_add_u32 v9, 61440, v8
    v_add_u32 v10, 61440, v11
    v_mov_b32 v12, 0
    v_mov_b32 v13, 0
    v_mov_b32 v14, 0
    v_mov_b32 v15, 0
    ds_read_b64_tr_b16 v[128:129], v8 offset:0
    ds_read_b64_tr_b16 v[130:131], v11 offset:0
    ds_read_b64_tr_b16 v[132:133], v8 offset:7168
    ds_read_b64_tr_b16 v[134:135], v11 offset:7168
    ds_read_b64_tr_b16 v[136:137], v8 offset:14336
    ds_read_b64_tr_b16 v[138:139], v11 offset:14336
    ds_read_b64_tr_b16 v[140:141], v8 offset:21504
    ds_read_b64_tr_b16 v[142:143], v11 offset:21504
    ds_read_b64_tr_b16 v[144:145], v8 offset:28672
    ds_read_b64_tr_b16 v[146:147], v11 offset:28672
    ds_read_b64_tr_b16 v[148:149], v8 offset:35840
    ds_read_b64_tr_b16 v[150:151], v11 offset:35840
    ds_read_b64_tr_b16 v[152:153], v8 offset:43008
    ds_read_b64_tr_b16 v[154:155], v11 offset:43008
    s_waitcnt lgkmcnt(0)
    v_mfma_f32_16x16x32_bf16 v[12:15], v[128:131], v[232:235], v[12:15]
    v_mfma_f32_16x16x32_bf16 v[12:15], v[132:135], v[232:235], v[12:15]
    v_mfma_f32_16x16x32_bf16 v[12:15], v[136:139], v[232:235], v[12:15]
    v_mfma_f32_16x16x32_bf16 v[12:15], v[140:143], v[232:235], v[12:15]
    v_mfma_f32_16x16x32_bf16 v[12:15], v[144:147], v[232:235], v[12:15]
    v_mfma_f32_16x16x32_bf16 v[12:15], v[148:151], v[232:235], v[12:15]
    v_mfma_f32_16x16x32_bf16 v[12:15], v[152:155], v[232:235], v[12:15]
    ds_read_b64_tr_b16 v[156:157], v8 offset:50176
    ds_read_b64_tr_b16 v[158:159], v11 offset:50176
    ds_read_b64_tr_b16 v[160:161], v8 offset:57344
    ds_read_b64_tr_b16 v[162:163], v11 offset:57344
    ds_read_b64_tr_b16 v[164:165], v9 offset:3072
    ds_read_b64_tr_b16 v[166:167], v10 offset:3072
    ds_read_b64_tr_b16 v[168:169], v9 offset:10240
    ds_read_b64_tr_b16 v[170:171], v10 offset:10240
    ds_read_b64_tr_b16 v[172:173], v9 offset:17408
    ds_read_b64_tr_b16 v[174:175], v10 offset:17408
    ds_read_b64_tr_b16 v[176:177], v9 offset:24576
    ds_read_b64_tr_b16 v[178:179], v10 offset:24576
    ds_read_b64_tr_b16 v[180:181], v9 offset:31744
    ds_read_b64_tr_b16 v[182:183], v10 offset:31744
    s_waitcnt lgkmcnt(0)
    v_mfma_f32_16x16x32_bf16 v[12:15], v[156:159], v[232:235], v[12:15]
    v_mfma_f32_16x16x32_bf16 v[12:15], v[160:163], v[232:235], v[12:15]
    v_mfma_f32_16x16x32_bf16 v[12:15], v[164:167], v[232:235], v[12:15]
    v_mfma_f32_16x16x32_bf16 v[12:15], v[168:171], v[232:235], v[12:15]
    v_mfma_f32_16x16x32_bf16 v[12:15], v[172:175], v[232:235], v[12:15]
    v_mfma_f32_16x16x32_bf16 v[12:15], v[176:179], v[232:235], v[12:15]
    v_mfma_f32_16x16x32_bf16 v[12:15], v[180:183], v[232:235], v[12:15]
    s_lshl_b32 s10, s10, 6
    v_lshlrev_b32 v8, 4, v3
    v_add_u32 v8, s10, v8
    v_add_u32 v8, 163328, v8
    s_mov_b32 exec_lo, 0x00010001
    s_mov_b32 exec_hi, 0x00010001
    s_nop 1
    ds_write_b128 v8, v[12:15]
    s_mov_b64 exec, -1
    s_waitcnt lgkmcnt(0)
L_cs_41:
    s_lshl_b32 s62, s3, 1
    s_add_u32 s63, s62, 1
    s_cmp_lg_u32 s5, 0
    s_cbranch_scc1 L_wd_42
    v_mov_b32 v8, s62
    v_mov_b32 v9, s63
    v_cmp_eq_u32 vcc, 1, v3
    s_nop 1
    v_cndmask_b32 v8, v8, v9, vcc
    s_lshl_b32 s10, s64, 3
    s_add_u32 s10, s10, 4
    s_lshl_b32 s10, s10, 12
    v_lshlrev_b32 v8, 7, v8
    v_lshl_add_u32 v8, v2, 3, v8
    v_add_u32 v8, s10, v8
    s_mov_b32 exec_lo, 0x7f007f
    s_mov_b32 exec_hi, 0x0
    s_mov_b32 s15, 0
    s_nop 5
L_poll_43:
    buffer_load_dwordx2 v[10:11], v8, s[92:95], 0 offen sc1
    s_waitcnt vmcnt(0)
    v_cmp_ne_u64 vcc, s[90:91], v[10:11]
    s_add_u32 s15, s15, 1
    s_cmp_gt_u32 s15, 0x40000
    s_cbranch_scc1 L_abort
    s_cmp_eq_u64 vcc, 0
    s_nop 2
    s_cbranch_scc1 L_poll_43_done
    s_sleep 1
    s_branch L_poll_43
L_poll_43_done:
    s_mov_b64 exec, -1
L_wd_42:
    s_barrier
    s_mul_i32 s10, s8, 896
    v_lshlrev_b32 v8, 4, v1
    v_add_u32 v8, s10, v8
    s_mov_b32 s10, 0
    buffer_load_dwordx4 v[72:75], v8, s[44:47], s10 offen
    s_mov_b32 s10, 1024
    buffer_load_dwordx4 v[76:79], v8, s[44:47], s10 offen
    s_mov_b32 s10, 2048
    buffer_load_dwordx4 v[80:83], v8, s[44:47], s10 offen
    s_mov_b32 s10, 3072
    buffer_load_dwordx4 v[84:87], v8, s[44:47], s10 offen
    s_mov_b32 s10, 4096
    buffer_load_dwordx4 v[88:91], v8, s[44:47], s10 offen
    s_mov_b32 s10, 5120
    buffer_load_dwordx4 v[92:95], v8, s[44:47], s10 offen
    s_mov_b32 s10, 6144
    buffer_load_dwordx4 v[96:99], v8, s[44:47], s10 offen
    s_mov_b32 s10, 7168
    buffer_load_dwordx4 v[100:103], v8, s[44:47], s10 offen
    s_mov_b32 s10, 8192
    buffer_load_dwordx4 v[104:107], v8, s[44:47], s10 offen
    s_mov_b32 s10, 9216
    buffer_load_dwordx4 v[108:111], v8, s[44:47], s10 offen
    s_mov_b32 s10, 10240
    buffer_load_dwordx4 v[112:115], v8, s[44:47], s10 offen
    s_mov_b32 s10, 11264
    buffer_load_dwordx4 v[116:119], v8, s[44:47], s10 offen
    s_mov_b32 s10, 12288
    buffer_load_dwordx4 v[120:123], v8, s[44:47], s10 offen
    s_mov_b32 s10, 13312
    buffer_load_dwordx4 v[124:127], v8, s[44:47], s10 offen
    s_mul_i32 s11, s5, 7168
    s_add_u32 s11, s11, 0
    v_and_b32 v9, 8, v2
    v_mul_u32_u24 v9, 896, v9
    v_sub_u32 v10, v243, v9
    v_sub_u32 v11, v244, v9
    v_add_u32 v10, s11, v10
    v_add_u32 v11, s11, v11
    v_add_u32 v212, s11, v236
    v_add_u32 v213, s11, v237
    v_add_u32 v214, s11, v238
    v_add_u32 v215, s11, v239
    v_add_u32 v216, s11, v240
    v_add_u32 v217, s11, v241
    v_add_u32 v218, s11, v242
    s_waitcnt vmcnt(13)
    ds_write_b128 v212, v[72:75]
    s_waitcnt vmcnt(12)
    ds_write_b128 v213, v[76:79]
    s_waitcnt vmcnt(11)
    ds_write_b128 v214, v[80:83]
    s_waitcnt vmcnt(10)
    ds_write_b128 v215, v[84:87]
    s_waitcnt vmcnt(9)
    ds_write_b128 v216, v[88:91]
    s_waitcnt vmcnt(8)
    ds_write_b128 v217, v[92:95]
    s_waitcnt vmcnt(7)
    ds_write_b128 v218, v[96:99]
    s_waitcnt lgkmcnt(0)
    s_mov_b32 exec_lo, 0x00ff00ff
    s_mov_b32 exec_hi, 0x00ff00ff
    ds_read_b128 v[16:19], v10 offset:0
    ds_read_b128 v[20:23], v11 offset:0
    ds_read_b128 v[24:27], v10 offset:128
    ds_read_b128 v[28:31], v11 offset:128
    ds_read_b128 v[32:35], v10 offset:256
    ds_read_b128 v[36:39], v11 offset:256
    ds_read_b128 v[40:43], v10 offset:384
    ds_read_b128 v[44:47], v11 offset:384
    ds_read_b128 v[48:51], v10 offset:512
    ds_read_b128 v[52:55], v11 offset:512
    ds_read_b128 v[56:59], v10 offset:640
    ds_read_b128 v[60:63], v11 offset:640
    ds_read_b128 v[64:67], v10 offset:768
    ds_read_b128 v[68:71], v11 offset:768
    s_waitcnt lgkmcnt(0)
    s_mov_b64 exec, -1
    v_xor_b32 v212, 64, v236
    v_add_u32 v212, s11, v212
    v_xor_b32 v213, 64, v237
    v_add_u32 v213, s11, v213
    v_xor_b32 v214, 64, v238
    v_add_u32 v214, s11, v214
    v_xor_b32 v215, 64, v239
    v_add_u32 v215, s11, v215
    v_xor_b32 v216, 64, v240
    v_add_u32 v216, s11, v216
    v_xor_b32 v217, 64, v241
    v_add_u32 v217, s11, v217
    v_xor_b32 v218, 64, v242
    v_add_u32 v218, s11, v218
    s_waitcnt vmcnt(6)
    ds_write_b128 v212, v[100:103]
    s_waitcnt vmcnt(5)
    ds_write_b128 v213, v[104:107]
    s_waitcnt vmcnt(4)
    ds_write_b128 v214, v[108:111]
    s_waitcnt vmcnt(3)
    ds_write_b128 v215, v[112:115]
    s_waitcnt vmcnt(2)
    ds_write_b128 v216, v[116:119]
    s_waitcnt vmcnt(1)
    ds_write_b128 v217, v[120:123]
    s_waitcnt vmcnt(0)
    ds_write_b128 v218, v[124:127]
    s_waitcnt lgkmcnt(0)
    s_mov_b32 exec_lo, 0xff00ff00
    s_mov_b32 exec_hi, 0xff00ff00
    ds_read_b128 v[16:19], v10 offset:0
    ds_read_b128 v[20:23], v11 offset:0
    ds_read_b128 v[24:27], v10 offset:128
    ds_read_b128 v[28:31], v11 offset:128
    ds_read_b128 v[32:35], v10 offset:256
    ds_read_b128 v[36:39], v11 offset:256
    ds_read_b128 v[40:43], v10 offset:384
    ds_read_b128 v[44:47], v11 offset:384
    ds_read_b128 v[48:51], v10 offset:512
    ds_read_b128 v[52:55], v11 offset:512
    ds_read_b128 v[56:59], v10 offset:640
    ds_read_b128 v[60:63], v11 offset:640
    ds_read_b128 v[64:67], v10 offset:768
    ds_read_b128 v[68:71], v11 offset:768
    s_waitcnt lgkmcnt(0)
    s_mov_b64 exec, -1
    v_mov_b32 v224, 0
    v_mov_b32 v225, 0
    v_mov_b32 v226, 0
    v_mov_b32 v227, 0
    v_dot2_f32_bf16 v224, v16, v232, v224
    v_dot2_f32_bf16 v226, v16, v16, v226
    v_dot2_f32_bf16 v225, v17, v232, v225
    v_dot2_f32_bf16 v227, v17, v17, v227
    v_dot2_f32_bf16 v224, v18, v232, v224
    v_dot2_f32_bf16 v226, v18, v18, v226
    v_dot2_f32_bf16 v225, v19, v232, v225
    v_dot2_f32_bf16 v227, v19, v19, v227
    v_dot2_f32_bf16 v224, v20, v232, v224
    v_dot2_f32_bf16 v226, v20, v20, v226
    v_dot2_f32_bf16 v225, v21, v232, v225
    v_dot2_f32_bf16 v227, v21, v21, v227
    v_dot2_f32_bf16 v224, v22, v232, v224
    v_dot2_f32_bf16 v226, v22, v22, v226
    v_dot2_f32_bf16 v225, v23, v232, v225
    v_dot2_f32_bf16 v227, v23, v23, v227
    v_dot2_f32_bf16 v224, v24, v232, v224
    v_dot2_f32_bf16 v226, v24, v24, v226
    v_dot2_f32_bf16 v225, v25, v232, v225
    v_dot2_f32_bf16 v227, v25, v25, v227
    v_dot2_f32_bf16 v224, v26, v232, v224
    v_dot2_f32_bf16 v226, v26, v26, v226
    v_dot2_f32_bf16 v225, v27, v232, v225
    v_dot2_f32_bf16 v227, v27, v27, v227
    v_dot2_f32_bf16 v224, v28, v232, v224
    v_dot2_f32_bf16 v226, v28, v28, v226
    v_dot2_f32_bf16 v225, v29, v232, v225
    v_dot2_f32_bf16 v227, v29, v29, v227
    v_dot2_f32_bf16 v224, v30, v232, v224
    v_dot2_f32_bf16 v226, v30, v30, v226
    v_dot2_f32_bf16 v225, v31, v232, v225
    v_dot2_f32_bf16 v227, v31, v31, v227
    v_dot2_f32_bf16 v224, v32, v232, v224
    v_dot2_f32_bf16 v226, v32, v32, v226
    v_dot2_f32_bf16 v225, v33, v232, v225
    v_dot2_f32_bf16 v227, v33, v33, v227
    v_dot2_f32_bf16 v224, v34, v232, v224
    v_dot2_f32_bf16 v226, v34, v34, v226
    v_dot2_f32_bf16 v225, v35, v232, v225
    v_dot2_f32_bf16 v227, v35, v35, v227
    v_dot2_f32_bf16 v224, v36, v232, v224
    v_dot2_f32_bf16 v226, v36, v36, v226
    v_dot2_f32_bf16 v225, v37, v232, v225
    v_dot2_f32_bf16 v227, v37, v37, v227
    v_dot2_f32_bf16 v224, v38, v232, v224
    v_dot2_f32_bf16 v226, v38, v38, v226
    v_dot2_f32_bf16 v225, v39, v232, v225
    v_dot2_f32_bf16 v227, v39, v39, v227
    v_dot2_f32_bf16 v224, v40, v232, v224
    v_dot2_f32_bf16 v226, v40, v40, v226
    v_dot2_f32_bf16 v225, v41, v232, v225
    v_dot2_f32_bf16 v227, v41, v41, v227
    v_dot2_f32_bf16 v224, v42, v232, v224
    v_dot2_f32_bf16 v226, v42, v42, v226
    v_dot2_f32_bf16 v225, v43, v232, v225
    v_dot2_f32_bf16 v227, v43, v43, v227
    v_dot2_f32_bf16 v224, v44, v232, v224
    v_dot2_f32_bf16 v226, v44, v44, v226
    v_dot2_f32_bf16 v225, v45, v232, v225
    v_dot2_f32_bf16 v227, v45, v45, v227
    v_dot2_f32_bf16 v224, v46, v232, v224
    v_dot2_f32_bf16 v226, v46, v46, v226
    v_dot2_f32_bf16 v225, v47, v232, v225
    v_dot2_f32_bf16 v227, v47, v47, v227
    v_dot2_f32_bf16 v224, v48, v232, v224
    v_dot2_f32_bf16 v226, v48, v48, v226
    v_dot2_f32_bf16 v225, v49, v232, v225
    v_dot2_f32_bf16 v227, v49, v49, v227
    v_dot2_f32_bf16 v224, v50, v232, v224
    v_dot2_f32_bf16 v226, v50, v50, v226
    v_dot2_f32_bf16 v225, v51, v232, v225
    v_dot2_f32_bf16 v227, v51, v51, v227
    v_dot2_f32_bf16 v224, v52, v232, v224
    v_dot2_f32_bf16 v226, v52, v52, v226
    v_dot2_f32_bf16 v225, v53, v232, v225
    v_dot2_f32_bf16 v227, v53, v53, v227
    v_dot2_f32_bf16 v224, v54, v232, v224
    v_dot2_f32_bf16 v226, v54, v54, v226
    v_dot2_f32_bf16 v225, v55, v232, v225
    v_dot2_f32_bf16 v227, v55, v55, v227
    v_dot2_f32_bf16 v224, v56, v232, v224
    v_dot2_f32_bf16 v226, v56, v56, v226
    v_dot2_f32_bf16 v225, v57, v232, v225
    v_dot2_f32_bf16 v227, v57, v57, v227
    v_dot2_f32_bf16 v224, v58, v232, v224
    v_dot2_f32_bf16 v226, v58, v58, v226
    v_dot2_f32_bf16 v225, v59, v232, v225
    v_dot2_f32_bf16 v227, v59, v59, v227
    v_dot2_f32_bf16 v224, v60, v232, v224
    v_dot2_f32_bf16 v226, v60, v60, v226
    v_dot2_f32_bf16 v225, v61, v232, v225
    v_dot2_f32_bf16 v227, v61, v61, v227
    v_dot2_f32_bf16 v224, v62, v232, v224
    v_dot2_f32_bf16 v226, v62, v62, v226
    v_dot2_f32_bf16 v225, v63, v232, v225
    v_dot2_f32_bf16 v227, v63, v63, v227
    v_dot2_f32_bf16 v224, v64, v232, v224
    v_dot2_f32_bf16 v226, v64, v64, v226
    v_dot2_f32_bf16 v225, v65, v232, v225
    v_dot2_f32_bf16 v227, v65, v65, v227
    v_dot2_f32_bf16 v224, v66, v232, v224
    v_dot2_f32_bf16 v226, v66, v66, v226
    v_dot2_f32_bf16 v225, v67, v232, v225
    v_dot2_f32_bf16 v227, v67, v67, v227
    v_dot2_f32_bf16 v224, v68, v232, v224
    v_dot2_f32_bf16 v226, v68, v68, v226
    v_dot2_f32_bf16 v225, v69, v232, v225
    v_dot2_f32_bf16 v227, v69, v69, v227
    v_dot2_f32_bf16 v224, v70, v232, v224
    v_dot2_f32_bf16 v226, v70, v70, v226
    v_dot2_f32_bf16 v225, v71, v232, v225
    v_dot2_f32_bf16 v227, v71, v71, v227
    s_nop 1
    v_add_f32 v224, v224, v225
    v_add_f32 v226, v226, v227
    v_mov_b32 v229, v224
    s_nop 1
    v_permlane16_swap_b32 v224, v229
    v_add_f32 v224, v224, v229
    v_mov_b32 v229, v224
    s_nop 1
    v_permlane32_swap_b32 v224, v229
    v_add_f32 v224, v224, v229
    v_mov_b32 v229, v226
    s_nop 1
    v_permlane16_swap_b32 v226, v229
    v_add_f32 v226, v226, v229
    v_mov_b32 v229, v226
    s_nop 1
    v_permlane32_swap_b32 v226, v229
    v_add_f32 v226, v226, v229
    v_mul_f32 v224, 0x3b124925, v224
    v_mul_f32 v226, 0x3b124925, v226
    v_fma_f32 v226, -v224, v224, v226
    v_max_f32 v226, 0, v226
    v_add_f32 v225, 0x3727c5ac, v226
    v_rsq_f32 v225, v225
    s_nop 0
    v_mov_b32 v226, v225
    v_mul_f32 v227, v224, v226
    v_sub_f32 v227, 0, v227
    v_lshl_add_u32 v10, v3, 3, v4
    v_mul_u32_u24 v10, 224, v10
    v_lshl_add_u32 v10, v5, 3, v10
    v_add_u32 v10, 0xe000, v10
    v_and_b32 v11, 1, v3
    v_mul_u32_u24 v11, 896, v11
    v_sub_u32 v12, v10, v11
    v_add_u32 v12, 896, v12
    v_add_u32 v10, v10, v11
    v_mov_b32 v11, v12
    v_add_u32 v212, 0xf000, v10
    v_add_u32 v213, 0xf000, v11
    s_mov_b32 s10, 3584
    v_mul_lo_u32 v13, v7, s10
    s_mul_i32 s10, s4, 224
    v_lshlrev_b32 v14, 3, v3
    v_add3_u32 v13, v13, v14, s10
    v_mov_b32 v184, 0
    v_mov_b32 v185, 0
    v_mov_b32 v186, 0
    v_mov_b32 v187, 0
    v_mov_b32 v188, 0
    v_mov_b32 v189, 0
    v_mov_b32 v190, 0
    v_mov_b32 v191, 0
    v_mov_b32 v192, 0
    v_mov_b32 v193, 0
    v_mov_b32 v194, 0
    v_mov_b32 v195, 0
    v_mov_b32 v196, 0
    v_mov_b32 v197, 0
    v_mov_b32 v198, 0
    v_mov_b32 v199, 0
    v_mov_b32 v200, 0
    v_mov_b32 v201, 0
    v_mov_b32 v202, 0
    v_mov_b32 v203, 0
    v_mov_b32 v204, 0
    v_mov_b32 v205, 0
    v_mov_b32 v206, 0
    v_mov_b32 v207, 0
    v_mov_b32 v208, 0
    v_mov_b32 v209, 0
    v_mov_b32 v210, 0
    v_mov_b32 v211, 0
    ds_read_b64_tr_b16 v[128:129], v10 offset:0
    ds_read_b64_tr_b16 v[130:131], v11 offset:0
    ds_read_b64_tr_b16 v[132:133], v10 offset:32
    ds_read_b64_tr_b16 v[134:135], v11 offset:32
    ds_read_b64_tr_b16 v[136:137], v10 offset:64
    ds_read_b64_tr_b16 v[138:139], v11 offset:64
    ds_read_b64_tr_b16 v[140:141], v10 offset:96
    ds_read_b64_tr_b16 v[142:143], v11 offset:96
    ds_read_b64_tr_b16 v[144:145], v10 offset:128
    ds_read_b64_tr_b16 v[146:147], v11 offset:128
    ds_read_b64_tr_b16 v[148:149], v10 offset:160
    ds_read_b64_tr_b16 v[150:151], v11 offset:160
    ds_read_b64_tr_b16 v[152:153], v10 offset:192
    ds_read_b64_tr_b16 v[154:155], v11 offset:192
    ds_read_b64_tr_b16 v[156:157], v10 offset:7168
    ds_read_b64_tr_b16 v[158:159], v11 offset:7168
    ds_read_b64_tr_b16 v[160:161], v10 offset:7200
    ds_read_b64_tr_b16 v[162:163], v11 offset:7200
    ds_read_b64_tr_b16 v[164:165], v10 offset:7232
    ds_read_b64_tr_b16 v[166:167], v11 offset:7232
    ds_read_b64_tr_b16 v[168:169], v10 offset:7264
    ds_read_b64_tr_b16 v[170:171], v11 offset:7264
    ds_read_b64_tr_b16 v[172:173], v10 offset:7296
    ds_read_b64_tr_b16 v[174:175], v11 offset:7296
    ds_read_b64_tr_b16 v[176:177], v10 offset:7328
    ds_read_b64_tr_b16 v[178:179], v11 offset:7328
    ds_read_b64_tr_b16 v[180:181], v10 offset:7360
    ds_read_b64_tr_b16 v[182:183], v11 offset:7360
    s_waitcnt lgkmcnt(14)
    v_mfma_f32_16x16x32_bf16 v[184:187], v[128:131], v[16:19], v[184:187]
    v_mfma_f32_16x16x32_bf16 v[188:191], v[132:135], v[16:19], v[188:191]
    v_mfma_f32_16x16x32_bf16 v[192:195], v[136:139], v[16:19], v[192:195]
    v_mfma_f32_16x16x32_bf16 v[196:199], v[140:143], v[16:19], v[196:199]
    v_mfma_f32_16x16x32_bf16 v[200:203], v[144:147], v[16:19], v[200:203]
    v_mfma_f32_16x16x32_bf16 v[204:207], v[148:151], v[16:19], v[204:207]
    v_mfma_f32_16x16x32_bf16 v[208:211], v[152:155], v[16:19], v[208:211]
    ds_read_b64_tr_b16 v[128:129], v10 offset:14336
    ds_read_b64_tr_b16 v[130:131], v11 offset:14336
    ds_read_b64_tr_b16 v[132:133], v10 offset:14368
    ds_read_b64_tr_b16 v[134:135], v11 offset:14368
    ds_read_b64_tr_b16 v[136:137], v10 offset:14400
    ds_read_b64_tr_b16 v[138:139], v11 offset:14400
    ds_read_b64_tr_b16 v[140:141], v10 offset:14432
    ds_read_b64_tr_b16 v[142:143], v11 offset:14432
    ds_read_b64_tr_b16 v[144:145], v10 offset:14464
    ds_read_b64_tr_b16 v[146:147], v11 offset:14464
    ds_read_b64_tr_b16 v[148:149], v10 offset:14496
    ds_read_b64_tr_b16 v[150:151], v11 offset:14496
    ds_read_b64_tr_b16 v[152:153], v10 offset:14528
    ds_read_b64_tr_b16 v[154:155], v11 offset:14528
    s_waitcnt lgkmcnt(14)
    v_mfma_f32_16x16x32_bf16 v[184:187], v[156:159], v[20:23], v[184:187]
    v_mfma_f32_16x16x32_bf16 v[188:191], v[160:163], v[20:23], v[188:191]
    v_mfma_f32_16x16x32_bf16 v[192:195], v[164:167], v[20:23], v[192:195]
    v_mfma_f32_16x16x32_bf16 v[196:199], v[168:171], v[20:23], v[196:199]
    v_mfma_f32_16x16x32_bf16 v[200:203], v[172:175], v[20:23], v[200:203]
    v_mfma_f32_16x16x32_bf16 v[204:207], v[176:179], v[20:23], v[204:207]
    v_mfma_f32_16x16x32_bf16 v[208:211], v[180:183], v[20:23], v[208:211]
    ds_read_b64_tr_b16 v[156:157], v10 offset:21504
    ds_read_b64_tr_b16 v[158:159], v11 offset:21504
    ds_read_b64_tr_b16 v[160:161], v10 offset:21536
    ds_read_b64_tr_b16 v[162:163], v11 offset:21536
    ds_read_b64_tr_b16 v[164:165], v10 offset:21568
    ds_read_b64_tr_b16 v[166:167], v11 offset:21568
    ds_read_b64_tr_b16 v[168:169], v10 offset:21600
    ds_read_b64_tr_b16 v[170:171], v11 offset:21600
    ds_read_b64_tr_b16 v[172:173], v10 offset:21632
    ds_read_b64_tr_b16 v[174:175], v11 offset:21632
    ds_read_b64_tr_b16 v[176:177], v10 offset:21664
    ds_read_b64_tr_b16 v[178:179], v11 offset:21664
    ds_read_b64_tr_b16 v[180:181], v10 offset:21696
    ds_read_b64_tr_b16 v[182:183], v11 offset:21696
    s_waitcnt lgkmcnt(14)
    v_mfma_f32_16x16x32_bf16 v[184:187], v[128:131], v[24:27], v[184:187]
    v_mfma_f32_16x16x32_bf16 v[188:191], v[132:135], v[24:27], v[188:191]
    v_mfma_f32_16x16x32_bf16 v[192:195], v[136:139], v[24:27], v[192:195]
    v_mfma_f32_16x16x32_bf16 v[196:199], v[140:143], v[24:27], v[196:199]
    v_mfma_f32_16x16x32_bf16 v[200:203], v[144:147], v[24:27], v[200:203]
    v_mfma_f32_16x16x32_bf16 v[204:207], v[148:151], v[24:27], v[204:207]
    v_mfma_f32_16x16x32_bf16 v[208:211], v[152:155], v[24:27], v[208:211]
    ds_read_b64_tr_b16 v[128:129], v10 offset:28672
    ds_read_b64_tr_b16 v[130:131], v11 offset:28672
    ds_read_b64_tr_b16 v[132:133], v10 offset:28704
    ds_read_b64_tr_b16 v[134:135], v11 offset:28704
    ds_read_b64_tr_b16 v[136:137], v10 offset:28736
    ds_read_b64_tr_b16 v[138:139], v11 offset:28736
    ds_read_b64_tr_b16 v[140:141], v10 offset:28768
    ds_read_b64_tr_b16 v[142:143], v11 offset:28768
    ds_read_b64_tr_b16 v[144:145], v10 offset:28800
    ds_read_b64_tr_b16 v[146:147], v11 offset:28800
    ds_read_b64_tr_b16 v[148:149], v10 offset:28832
    ds_read_b64_tr_b16 v[150:151], v11 offset:28832
    ds_read_b64_tr_b16 v[152:153], v10 offset:28864
    ds_read_b64_tr_b16 v[154:155], v11 offset:28864
    s_waitcnt lgkmcnt(14)
    v_mfma_f32_16x16x32_bf16 v[184:187], v[156:159], v[28:31], v[184:187]
    v_mfma_f32_16x16x32_bf16 v[188:191], v[160:163], v[28:31], v[188:191]
    v_mfma_f32_16x16x32_bf16 v[192:195], v[164:167], v[28:31], v[192:195]
    v_mfma_f32_16x16x32_bf16 v[196:199], v[168:171], v[28:31], v[196:199]
    v_mfma_f32_16x16x32_bf16 v[200:203], v[172:175], v[28:31], v[200:203]
    v_mfma_f32_16x16x32_bf16 v[204:207], v[176:179], v[28:31], v[204:207]
    v_mfma_f32_16x16x32_bf16 v[208:211], v[180:183], v[28:31], v[208:211]
    ds_read_b64_tr_b16 v[156:157], v10 offset:35840
    ds_read_b64_tr_b16 v[158:159], v11 offset:35840
    ds_read_b64_tr_b16 v[160:161], v10 offset:35872
    ds_read_b64_tr_b16 v[162:163], v11 offset:35872
    ds_read_b64_tr_b16 v[164:165], v10 offset:35904
    ds_read_b64_tr_b16 v[166:167], v11 offset:35904
    ds_read_b64_tr_b16 v[168:169], v10 offset:35936
    ds_read_b64_tr_b16 v[170:171], v11 offset:35936
    ds_read_b64_tr_b16 v[172:173], v10 offset:35968
    ds_read_b64_tr_b16 v[174:175], v11 offset:35968
    ds_read_b64_tr_b16 v[176:177], v10 offset:36000
    ds_read_b64_tr_b16 v[178:179], v11 offset:36000
    ds_read_b64_tr_b16 v[180:181], v10 offset:36032
    ds_read_b64_tr_b16 v[182:183], v11 offset:36032
    s_waitcnt lgkmcnt(14)
    v_mfma_f32_16x16x32_bf16 v[184:187], v[128:131], v[32:35], v[184:187]
    v_mfma_f32_16x16x32_bf16 v[188:191], v[132:135], v[32:35], v[188:191]
    v_mfma_f32_16x16x32_bf16 v[192:195], v[136:139], v[32:35], v[192:195]
    v_mfma_f32_16x16x32_bf16 v[196:199], v[140:143], v[32:35], v[196:199]
    v_mfma_f32_16x16x32_bf16 v[200:203], v[144:147], v[32:35], v[200:203]
    v_mfma_f32_16x16x32_bf16 v[204:207], v[148:151], v[32:35], v[204:207]
    v_mfma_f32_16x16x32_bf16 v[208:211], v[152:155], v[32:35], v[208:211]
    ds_read_b64_tr_b16 v[128:129], v10 offset:43008
    ds_read_b64_tr_b16 v[130:131], v11 offset:43008
    ds_read_b64_tr_b16 v[132:133], v10 offset:43040
    ds_read_b64_tr_b16 v[134:135], v11 offset:43040
    ds_read_b64_tr_b16 v[136:137], v10 offset:43072
    ds_read_b64_tr_b16 v[138:139], v11 offset:43072
    ds_read_b64_tr_b16 v[140:141], v10 offset:43104
    ds_read_b64_tr_b16 v[142:143], v11 offset:43104
    ds_read_b64_tr_b16 v[144:145], v10 offset:43136
    ds_read_b64_tr_b16 v[146:147], v11 offset:43136
    ds_read_b64_tr_b16 v[148:149], v10 offset:43168
    ds_read_b64_tr_b16 v[150:151], v11 offset:43168
    ds_read_b64_tr_b16 v[152:153], v10 offset:43200
    ds_read_b64_tr_b16 v[154:155], v11 offset:43200
    s_waitcnt lgkmcnt(14)
    v_mfma_f32_16x16x32_bf16 v[184:187], v[156:159], v[36:39], v[184:187]
    v_mfma_f32_16x16x32_bf16 v[188:191], v[160:163], v[36:39], v[188:191]
    v_mfma_f32_16x16x32_bf16 v[192:195], v[164:167], v[36:39], v[192:195]
    v_mfma_f32_16x16x32_bf16 v[196:199], v[168:171], v[36:39], v[196:199]
    v_mfma_f32_16x16x32_bf16 v[200:203], v[172:175], v[36:39], v[200:203]
    v_mfma_f32_16x16x32_bf16 v[204:207], v[176:179], v[36:39], v[204:207]
    v_mfma_f32_16x16x32_bf16 v[208:211], v[180:183], v[36:39], v[208:211]
    ds_read_b64_tr_b16 v[156:157], v10 offset:50176
    ds_read_b64_tr_b16 v[158:159], v11 offset:50176
    ds_read_b64_tr_b16 v[160:161], v10 offset:50208
    ds_read_b64_tr_b16 v[162:163], v11 offset:50208
    ds_read_b64_tr_b16 v[164:165], v10 offset:50240
    ds_read_b64_tr_b16 v[166:167], v11 offset:50240
    ds_read_b64_tr_b16 v[168:169], v10 offset:50272
    ds_read_b64_tr_b16 v[170:171], v11 offset:50272
    ds_read_b64_tr_b16 v[172:173], v10 offset:50304
    ds_read_b64_tr_b16 v[174:175], v11 offset:50304
    ds_read_b64_tr_b16 v[176:177], v10 offset:50336
    ds_read_b64_tr_b16 v[178:179], v11 offset:50336
    ds_read_b64_tr_b16 v[180:181], v10 offset:50368
    ds_read_b64_tr_b16 v[182:183], v11 offset:50368
    s_waitcnt lgkmcnt(14)
    v_mfma_f32_16x16x32_bf16 v[184:187], v[128:131], v[40:43], v[184:187]
    v_mfma_f32_16x16x32_bf16 v[188:191], v[132:135], v[40:43], v[188:191]
    v_mfma_f32_16x16x32_bf16 v[192:195], v[136:139], v[40:43], v[192:195]
    v_mfma_f32_16x16x32_bf16 v[196:199], v[140:143], v[40:43], v[196:199]
    v_mfma_f32_16x16x32_bf16 v[200:203], v[144:147], v[40:43], v[200:203]
    v_mfma_f32_16x16x32_bf16 v[204:207], v[148:151], v[40:43], v[204:207]
    v_mfma_f32_16x16x32_bf16 v[208:211], v[152:155], v[40:43], v[208:211]
    ds_read_b64_tr_b16 v[128:129], v10 offset:57344
    ds_read_b64_tr_b16 v[130:131], v11 offset:57344
    ds_read_b64_tr_b16 v[132:133], v10 offset:57376
    ds_read_b64_tr_b16 v[134:135], v11 offset:57376
    ds_read_b64_tr_b16 v[136:137], v10 offset:57408
    ds_read_b64_tr_b16 v[138:139], v11 offset:57408
    ds_read_b64_tr_b16 v[140:141], v10 offset:57440
    ds_read_b64_tr_b16 v[142:143], v11 offset:57440
    ds_read_b64_tr_b16 v[144:145], v10 offset:57472
    ds_read_b64_tr_b16 v[146:147], v11 offset:57472
    ds_read_b64_tr_b16 v[148:149], v10 offset:57504
    ds_read_b64_tr_b16 v[150:151], v11 offset:57504
    ds_read_b64_tr_b16 v[152:153], v10 offset:57536
    ds_read_b64_tr_b16 v[154:155], v11 offset:57536
    s_waitcnt lgkmcnt(14)
    v_mfma_f32_16x16x32_bf16 v[184:187], v[156:159], v[44:47], v[184:187]
    v_mfma_f32_16x16x32_bf16 v[188:191], v[160:163], v[44:47], v[188:191]
    v_mfma_f32_16x16x32_bf16 v[192:195], v[164:167], v[44:47], v[192:195]
    v_mfma_f32_16x16x32_bf16 v[196:199], v[168:171], v[44:47], v[196:199]
    v_mfma_f32_16x16x32_bf16 v[200:203], v[172:175], v[44:47], v[200:203]
    v_mfma_f32_16x16x32_bf16 v[204:207], v[176:179], v[44:47], v[204:207]
    v_mfma_f32_16x16x32_bf16 v[208:211], v[180:183], v[44:47], v[208:211]
    ds_read_b64_tr_b16 v[156:157], v212 offset:3072
    ds_read_b64_tr_b16 v[158:159], v213 offset:3072
    ds_read_b64_tr_b16 v[160:161], v212 offset:3104
    ds_read_b64_tr_b16 v[162:163], v213 offset:3104
    ds_read_b64_tr_b16 v[164:165], v212 offset:3136
    ds_read_b64_tr_b16 v[166:167], v213 offset:3136
    ds_read_b64_tr_b16 v[168:169], v212 offset:3168
    ds_read_b64_tr_b16 v[170:171], v213 offset:3168
    ds_read_b64_tr_b16 v[172:173], v212 offset:3200
    ds_read_b64_tr_b16 v[174:175], v213 offset:3200
    ds_read_b64_tr_b16 v[176:177], v212 offset:3232
    ds_read_b64_tr_b16 v[178:179], v213 offset:3232
    ds_read_b64_tr_b16 v[180:181], v212 offset:3264
    ds_read_b64_tr_b16 v[182:183], v213 offset:3264
    s_waitcnt lgkmcnt(14)
    v_mfma_f32_16x16x32_bf16 v[184:187], v[128:131], v[48:51], v[184:187]
    v_mfma_f32_16x16x32_bf16 v[188:191], v[132:135], v[48:51], v[188:191]
    v_mfma_f32_16x16x32_bf16 v[192:195], v[136:139], v[48:51], v[192:195]
    v_mfma_f32_16x16x32_bf16 v[196:199], v[140:143], v[48:51], v[196:199]
    v_mfma_f32_16x16x32_bf16 v[200:203], v[144:147], v[48:51], v[200:203]
    v_mfma_f32_16x16x32_bf16 v[204:207], v[148:151], v[48:51], v[204:207]
    v_mfma_f32_16x16x32_bf16 v[208:211], v[152:155], v[48:51], v[208:211]
    ds_read_b64_tr_b16 v[128:129], v212 offset:10240
    ds_read_b64_tr_b16 v[130:131], v213 offset:10240
    ds_read_b64_tr_b16 v[132:133], v212 offset:10272
    ds_read_b64_tr_b16 v[134:135], v213 offset:10272
    ds_read_b64_tr_b16 v[136:137], v212 offset:10304
    ds_read_b64_tr_b16 v[138:139], v213 offset:10304
    ds_read_b64_tr_b16 v[140:141], v212 offset:10336
    ds_read_b64_tr_b16 v[142:143], v213 offset:10336
    ds_read_b64_tr_b16 v[144:145], v212 offset:10368
    ds_read_b64_tr_b16 v[146:147], v213 offset:10368
    ds_read_b64_tr_b16 v[148:149], v212 offset:10400
    ds_read_b64_tr_b16 v[150:151], v213 offset:10400
    ds_read_b64_tr_b16 v[152:153], v212 offset:10432
    ds_read_b64_tr_b16 v[154:155], v213 offset:10432
    s_waitcnt lgkmcnt(14)
    v_mfma_f32_16x16x32_bf16 v[184:187], v[156:159], v[52:55], v[184:187]
    v_mfma_f32_16x16x32_bf16 v[188:191], v[160:163], v[52:55], v[188:191]
    v_mfma_f32_16x16x32_bf16 v[192:195], v[164:167], v[52:55], v[192:195]
    v_mfma_f32_16x16x32_bf16 v[196:199], v[168:171], v[52:55], v[196:199]
    v_mfma_f32_16x16x32_bf16 v[200:203], v[172:175], v[52:55], v[200:203]
    v_mfma_f32_16x16x32_bf16 v[204:207], v[176:179], v[52:55], v[204:207]
    v_mfma_f32_16x16x32_bf16 v[208:211], v[180:183], v[52:55], v[208:211]
    ds_read_b64_tr_b16 v[156:157], v212 offset:17408
    ds_read_b64_tr_b16 v[158:159], v213 offset:17408
    ds_read_b64_tr_b16 v[160:161], v212 offset:17440
    ds_read_b64_tr_b16 v[162:163], v213 offset:17440
    ds_read_b64_tr_b16 v[164:165], v212 offset:17472
    ds_read_b64_tr_b16 v[166:167], v213 offset:17472
    ds_read_b64_tr_b16 v[168:169], v212 offset:17504
    ds_read_b64_tr_b16 v[170:171], v213 offset:17504
    ds_read_b64_tr_b16 v[172:173], v212 offset:17536
    ds_read_b64_tr_b16 v[174:175], v213 offset:17536
    ds_read_b64_tr_b16 v[176:177], v212 offset:17568
    ds_read_b64_tr_b16 v[178:179], v213 offset:17568
    ds_read_b64_tr_b16 v[180:181], v212 offset:17600
    ds_read_b64_tr_b16 v[182:183], v213 offset:17600
    s_waitcnt lgkmcnt(14)
    v_mfma_f32_16x16x32_bf16 v[184:187], v[128:131], v[56:59], v[184:187]
    v_mfma_f32_16x16x32_bf16 v[188:191], v[132:135], v[56:59], v[188:191]
    v_mfma_f32_16x16x32_bf16 v[192:195], v[136:139], v[56:59], v[192:195]
    v_mfma_f32_16x16x32_bf16 v[196:199], v[140:143], v[56:59], v[196:199]
    v_mfma_f32_16x16x32_bf16 v[200:203], v[144:147], v[56:59], v[200:203]
    v_mfma_f32_16x16x32_bf16 v[204:207], v[148:151], v[56:59], v[204:207]
    v_mfma_f32_16x16x32_bf16 v[208:211], v[152:155], v[56:59], v[208:211]
    ds_read_b64_tr_b16 v[128:129], v212 offset:24576
    ds_read_b64_tr_b16 v[130:131], v213 offset:24576
    ds_read_b64_tr_b16 v[132:133], v212 offset:24608
    ds_read_b64_tr_b16 v[134:135], v213 offset:24608
    ds_read_b64_tr_b16 v[136:137], v212 offset:24640
    ds_read_b64_tr_b16 v[138:139], v213 offset:24640
    ds_read_b64_tr_b16 v[140:141], v212 offset:24672
    ds_read_b64_tr_b16 v[142:143], v213 offset:24672
    ds_read_b64_tr_b16 v[144:145], v212 offset:24704
    ds_read_b64_tr_b16 v[146:147], v213 offset:24704
    ds_read_b64_tr_b16 v[148:149], v212 offset:24736
    ds_read_b64_tr_b16 v[150:151], v213 offset:24736
    ds_read_b64_tr_b16 v[152:153], v212 offset:24768
    ds_read_b64_tr_b16 v[154:155], v213 offset:24768
    s_waitcnt lgkmcnt(14)
    v_mfma_f32_16x16x32_bf16 v[184:187], v[156:159], v[60:63], v[184:187]
    v_mfma_f32_16x16x32_bf16 v[188:191], v[160:163], v[60:63], v[188:191]
    v_mfma_f32_16x16x32_bf16 v[192:195], v[164:167], v[60:63], v[192:195]
    v_mfma_f32_16x16x32_bf16 v[196:199], v[168:171], v[60:63], v[196:199]
    v_mfma_f32_16x16x32_bf16 v[200:203], v[172:175], v[60:63], v[200:203]
    v_mfma_f32_16x16x32_bf16 v[204:207], v[176:179], v[60:63], v[204:207]
    v_mfma_f32_16x16x32_bf16 v[208:211], v[180:183], v[60:63], v[208:211]
    ds_read_b64_tr_b16 v[156:157], v212 offset:31744
    ds_read_b64_tr_b16 v[158:159], v213 offset:31744
    ds_read_b64_tr_b16 v[160:161], v212 offset:31776
    ds_read_b64_tr_b16 v[162:163], v213 offset:31776
    ds_read_b64_tr_b16 v[164:165], v212 offset:31808
    ds_read_b64_tr_b16 v[166:167], v213 offset:31808
    ds_read_b64_tr_b16 v[168:169], v212 offset:31840
    ds_read_b64_tr_b16 v[170:171], v213 offset:31840
    ds_read_b64_tr_b16 v[172:173], v212 offset:31872
    ds_read_b64_tr_b16 v[174:175], v213 offset:31872
    ds_read_b64_tr_b16 v[176:177], v212 offset:31904
    ds_read_b64_tr_b16 v[178:179], v213 offset:31904
    ds_read_b64_tr_b16 v[180:181], v212 offset:31936
    ds_read_b64_tr_b16 v[182:183], v213 offset:31936
    s_waitcnt lgkmcnt(14)
    v_mfma_f32_16x16x32_bf16 v[184:187], v[128:131], v[64:67], v[184:187]
    v_mfma_f32_16x16x32_bf16 v[188:191], v[132:135], v[64:67], v[188:191]
    v_mfma_f32_16x16x32_bf16 v[192:195], v[136:139], v[64:67], v[192:195]
    v_mfma_f32_16x16x32_bf16 v[196:199], v[140:143], v[64:67], v[196:199]
    v_mfma_f32_16x16x32_bf16 v[200:203], v[144:147], v[64:67], v[200:203]
    v_mfma_f32_16x16x32_bf16 v[204:207], v[148:151], v[64:67], v[204:207]
    v_mfma_f32_16x16x32_bf16 v[208:211], v[152:155], v[64:67], v[208:211]
    s_waitcnt lgkmcnt(0)
    v_mfma_f32_16x16x32_bf16 v[184:187], v[156:159], v[68:71], v[184:187]
    v_mfma_f32_16x16x32_bf16 v[188:191], v[160:163], v[68:71], v[188:191]
    v_mfma_f32_16x16x32_bf16 v[192:195], v[164:167], v[68:71], v[192:195]
    v_mfma_f32_16x16x32_bf16 v[196:199], v[168:171], v[68:71], v[196:199]
    v_mfma_f32_16x16x32_bf16 v[200:203], v[172:175], v[68:71], v[200:203]
    v_mfma_f32_16x16x32_bf16 v[204:207], v[176:179], v[68:71], v[204:207]
    v_mfma_f32_16x16x32_bf16 v[208:211], v[180:183], v[68:71], v[208:211]
    v_lshlrev_b32 v9, 4, v3
    v_add_u32 v9, 163328, v9
    ds_read_b128 v[72:75], v9 offset:0
    ds_read_b128 v[76:79], v9 offset:64
    ds_read_b128 v[80:83], v9 offset:128
    ds_read_b128 v[84:87], v9 offset:192
    ds_read_b128 v[88:91], v9 offset:256
    ds_read_b128 v[92:95], v9 offset:320
    ds_read_b128 v[96:99], v9 offset:384
    s_waitcnt lgkmcnt(0)
    v_mul_f32 v184, v184, v226
    v_fmac_f32 v184, v72, v227
    v_mul_f32 v185, v185, v226
    v_fmac_f32 v185, v73, v227
    v_mul_f32 v186, v186, v226
    v_fmac_f32 v186, v74, v227
    v_mul_f32 v187, v187, v226
    v_fmac_f32 v187, v75, v227
    v_mul_f32 v188, v188, v226
    v_fmac_f32 v188, v76, v227
    v_mul_f32 v189, v189, v226
    v_fmac_f32 v189, v77, v227
    v_mul_f32 v190, v190, v226
    v_fmac_f32 v190, v78, v227
    v_mul_f32 v191, v191, v226
    v_fmac_f32 v191, v79, v227
    v_mul_f32 v192, v192, v226
    v_fmac_f32 v192, v80, v227
    v_mul_f32 v193, v193, v226
    v_fmac_f32 v193, v81, v227
    v_mul_f32 v194, v194, v226
    v_fmac_f32 v194, v82, v227
    v_mul_f32 v195, v195, v226
    v_fmac_f32 v195, v83, v227
    v_mul_f32 v196, v196, v226
    v_fmac_f32 v196, v84, v227
    v_mul_f32 v197, v197, v226
    v_fmac_f32 v197, v85, v227
    v_mul_f32 v198, v198, v226
    v_fmac_f32 v198, v86, v227
    v_mul_f32 v199, v199, v226
    v_fmac_f32 v199, v87, v227
    v_mul_f32 v200, v200, v226
    v_fmac_f32 v200, v88, v227
    v_mul_f32 v201, v201, v226
    v_fmac_f32 v201, v89, v227
    v_mul_f32 v202, v202, v226
    v_fmac_f32 v202, v90, v227
    v_mul_f32 v203, v203, v226
    v_fmac_f32 v203, v91, v227
    v_mul_f32 v204, v204, v226
    v_fmac_f32 v204, v92, v227
    v_mul_f32 v205, v205, v226
    v_fmac_f32 v205, v93, v227
    v_mul_f32 v206, v206, v226
    v_fmac_f32 v206, v94, v227
    v_mul_f32 v207, v207, v226
    v_fmac_f32 v207, v95, v227
    v_mul_f32 v208, v208, v226
    v_fmac_f32 v208, v96, v227
    v_mul_f32 v209, v209, v226
    v_fmac_f32 v209, v97, v227
    v_mul_f32 v210, v210, v226
    v_fmac_f32 v210, v98, v227
    v_mul_f32 v211, v211, v226
    v_fmac_f32 v211, v99, v227
    v_lshlrev_b32 v14, 3, v3
    v_sub_u32 v14, v13, v14
    v_and_b32 v245, 1, v3
    v_lshl_add_u32 v14, v245, 5, v14
    v_lshrrev_b32 v245, 1, v3
    v_lshl_add_u32 v14, v245, 4, v14
    v_mul_f32 v212, v184, v184
    v_mov_b32 v213, 0xc0135761
    v_fmac_f32 v213, 0xbdd2d3e8, v212
    v_mul_f32 v212, v213, v184
    v_exp_f32 v212, v212
    s_nop 0
    v_add_f32 v212, 1.0, v212
    v_rcp_f32 v212, v212
    s_nop 0
    v_mul_f32 v184, v184, v212
    v_mul_f32 v214, v185, v185
    v_mov_b32 v215, 0xc0135761
    v_fmac_f32 v215, 0xbdd2d3e8, v214
    v_mul_f32 v214, v215, v185
    v_exp_f32 v214, v214
    s_nop 0
    v_add_f32 v214, 1.0, v214
    v_rcp_f32 v214, v214
    s_nop 0
    v_mul_f32 v185, v185, v214
    v_mul_f32 v216, v186, v186
    v_mov_b32 v217, 0xc0135761
    v_fmac_f32 v217, 0xbdd2d3e8, v216
    v_mul_f32 v216, v217, v186
    v_exp_f32 v216, v216
    s_nop 0
    v_add_f32 v216, 1.0, v216
    v_rcp_f32 v216, v216
    s_nop 0
    v_mul_f32 v186, v186, v216
    v_mul_f32 v218, v187, v187
    v_mov_b32 v219, 0xc0135761
    v_fmac_f32 v219, 0xbdd2d3e8, v218
    v_mul_f32 v218, v219, v187
    v_exp_f32 v218, v218
    s_nop 0
    v_add_f32 v218, 1.0, v218
    v_rcp_f32 v218, v218
    s_nop 0
    v_mul_f32 v187, v187, v218
    v_cvt_pk_bf16_f32 v16, v184, v185
    v_cvt_pk_bf16_f32 v17, v186, v187
    v_mul_f32 v212, v188, v188
    v_mov_b32 v213, 0xc0135761
    v_fmac_f32 v213, 0xbdd2d3e8, v212
    v_mul_f32 v212, v213, v188
    v_exp_f32 v212, v212
    s_nop 0
    v_add_f32 v212, 1.0, v212
    v_rcp_f32 v212, v212
    s_nop 0
    v_mul_f32 v188, v188, v212
    v_mul_f32 v214, v189, v189
    v_mov_b32 v215, 0xc0135761
    v_fmac_f32 v215, 0xbdd2d3e8, v214
    v_mul_f32 v214, v215, v189
    v_exp_f32 v214, v214
    s_nop 0
    v_add_f32 v214, 1.0, v214
    v_rcp_f32 v214, v214
    s_nop 0
    v_mul_f32 v189, v189, v214
    v_mul_f32 v216, v190, v190
    v_mov_b32 v217, 0xc0135761
    v_fmac_f32 v217, 0xbdd2d3e8, v216
    v_mul_f32 v216, v217, v190
    v_exp_f32 v216, v216
    s_nop 0
    v_add_f32 v216, 1.0, v216
    v_rcp_f32 v216, v216
    s_nop 0
    v_mul_f32 v190, v190, v216
    v_mul_f32 v218, v191, v191
    v_mov_b32 v219, 0xc0135761
    v_fmac_f32 v219, 0xbdd2d3e8, v218
    v_mul_f32 v218, v219, v191
    v_exp_f32 v218, v218
    s_nop 0
    v_add_f32 v218, 1.0, v218
    v_rcp_f32 v218, v218
    s_nop 0
    v_mul_f32 v191, v191, v218
    v_cvt_pk_bf16_f32 v18, v188, v189
    v_cvt_pk_bf16_f32 v19, v190, v191
    s_nop 0
    v_permlane16_swap_b32 v16, v18
    v_permlane16_swap_b32 v17, v19
    buffer_store_dwordx4 v[16:19], v14, s[52:55], 0 offen offset:0 sc1
    v_mul_f32 v212, v192, v192
    v_mov_b32 v213, 0xc0135761
    v_fmac_f32 v213, 0xbdd2d3e8, v212
    v_mul_f32 v212, v213, v192
    v_exp_f32 v212, v212
    s_nop 0
    v_add_f32 v212, 1.0, v212
    v_rcp_f32 v212, v212
    s_nop 0
    v_mul_f32 v192, v192, v212
    v_mul_f32 v214, v193, v193
    v_mov_b32 v215, 0xc0135761
    v_fmac_f32 v215, 0xbdd2d3e8, v214
    v_mul_f32 v214, v215, v193
    v_exp_f32 v214, v214
    s_nop 0
    v_add_f32 v214, 1.0, v214
    v_rcp_f32 v214, v214
    s_nop 0
    v_mul_f32 v193, v193, v214
    v_mul_f32 v216, v194, v194
    v_mov_b32 v217, 0xc0135761
    v_fmac_f32 v217, 0xbdd2d3e8, v216
    v_mul_f32 v216, v217, v194
    v_exp_f32 v216, v216
    s_nop 0
    v_add_f32 v216, 1.0, v216
    v_rcp_f32 v216, v216
    s_nop 0
    v_mul_f32 v194, v194, v216
    v_mul_f32 v218, v195, v195
    v_mov_b32 v219, 0xc0135761
    v_fmac_f32 v219, 0xbdd2d3e8, v218
    v_mul_f32 v218, v219, v195
    v_exp_f32 v218, v218
    s_nop 0
    v_add_f32 v218, 1.0, v218
    v_rcp_f32 v218, v218
    s_nop 0
    v_mul_f32 v195, v195, v218
    v_cvt_pk_bf16_f32 v20, v192, v193
    v_cvt_pk_bf16_f32 v21, v194, v195
    v_mul_f32 v212, v196, v196
    v_mov_b32 v213, 0xc0135761
    v_fmac_f32 v213, 0xbdd2d3e8, v212
    v_mul_f32 v212, v213, v196
    v_exp_f32 v212, v212
    s_nop 0
    v_add_f32 v212, 1.0, v212
    v_rcp_f32 v212, v212
    s_nop 0
    v_mul_f32 v196, v196, v212
    v_mul_f32 v214, v197, v197
    v_mov_b32 v215, 0xc0135761
    v_fmac_f32 v215, 0xbdd2d3e8, v214
    v_mul_f32 v214, v215, v197
    v_exp_f32 v214, v214
    s_nop 0
    v_add_f32 v214, 1.0, v214
    v_rcp_f32 v214, v214
    s_nop 0
    v_mul_f32 v197, v197, v214
    v_mul_f32 v216, v198, v198
    v_mov_b32 v217, 0xc0135761
    v_fmac_f32 v217, 0xbdd2d3e8, v216
    v_mul_f32 v216, v217, v198
    v_exp_f32 v216, v216
    s_nop 0
    v_add_f32 v216, 1.0, v216
    v_rcp_f32 v216, v216
    s_nop 0
    v_mul_f32 v198, v198, v216
    v_mul_f32 v218, v199, v199
    v_mov_b32 v219, 0xc0135761
    v_fmac_f32 v219, 0xbdd2d3e8, v218
    v_mul_f32 v218, v219, v199
    v_exp_f32 v218, v218
    s_nop 0
    v_add_f32 v218, 1.0, v218
    v_rcp_f32 v218, v218
    s_nop 0
    v_mul_f32 v199, v199, v218
    v_cvt_pk_bf16_f32 v22, v196, v197
    v_cvt_pk_bf16_f32 v23, v198, v199
    s_nop 0
    v_permlane16_swap_b32 v20, v22
    v_permlane16_swap_b32 v21, v23
    buffer_store_dwordx4 v[20:23], v14, s[52:55], 0 offen offset:64 sc1
    v_mul_f32 v212, v200, v200
    v_mov_b32 v213, 0xc0135761
    v_fmac_f32 v213, 0xbdd2d3e8, v212
    v_mul_f32 v212, v213, v200
    v_exp_f32 v212, v212
    s_nop 0
    v_add_f32 v212, 1.0, v212
    v_rcp_f32 v212, v212
    s_nop 0
    v_mul_f32 v200, v200, v212
    v_mul_f32 v214, v201, v201
    v_mov_b32 v215, 0xc0135761
    v_fmac_f32 v215, 0xbdd2d3e8, v214
    v_mul_f32 v214, v215, v201
    v_exp_f32 v214, v214
    s_nop 0
    v_add_f32 v214, 1.0, v214
    v_rcp_f32 v214, v214
    s_nop 0
    v_mul_f32 v201, v201, v214
    v_mul_f32 v216, v202, v202
    v_mov_b32 v217, 0xc0135761
    v_fmac_f32 v217, 0xbdd2d3e8, v216
    v_mul_f32 v216, v217, v202
    v_exp_f32 v216, v216
    s_nop 0
    v_add_f32 v216, 1.0, v216
    v_rcp_f32 v216, v216
    s_nop 0
    v_mul_f32 v202, v202, v216
    v_mul_f32 v218, v203, v203
    v_mov_b32 v219, 0xc0135761
    v_fmac_f32 v219, 0xbdd2d3e8, v218
    v_mul_f32 v218, v219, v203
    v_exp_f32 v218, v218
    s_nop 0
    v_add_f32 v218, 1.0, v218
    v_rcp_f32 v218, v218
    s_nop 0
    v_mul_f32 v203, v203, v218
    v_cvt_pk_bf16_f32 v24, v200, v201
    v_cvt_pk_bf16_f32 v25, v202, v203
    v_mul_f32 v212, v204, v204
    v_mov_b32 v213, 0xc0135761
    v_fmac_f32 v213, 0xbdd2d3e8, v212
    v_mul_f32 v212, v213, v204
    v_exp_f32 v212, v212
    s_nop 0
    v_add_f32 v212, 1.0, v212
    v_rcp_f32 v212, v212
    s_nop 0
    v_mul_f32 v204, v204, v212
    v_mul_f32 v214, v205, v205
    v_mov_b32 v215, 0xc0135761
    v_fmac_f32 v215, 0xbdd2d3e8, v214
    v_mul_f32 v214, v215, v205
    v_exp_f32 v214, v214
    s_nop 0
    v_add_f32 v214, 1.0, v214
    v_rcp_f32 v214, v214
    s_nop 0
    v_mul_f32 v205, v205, v214
    v_mul_f32 v216, v206, v206
    v_mov_b32 v217, 0xc0135761
    v_fmac_f32 v217, 0xbdd2d3e8, v216
    v_mul_f32 v216, v217, v206
    v_exp_f32 v216, v216
    s_nop 0
    v_add_f32 v216, 1.0, v216
    v_rcp_f32 v216, v216
    s_nop 0
    v_mul_f32 v206, v206, v216
    v_mul_f32 v218, v207, v207
    v_mov_b32 v219, 0xc0135761
    v_fmac_f32 v219, 0xbdd2d3e8, v218
    v_mul_f32 v218, v219, v207
    v_exp_f32 v218, v218
    s_nop 0
    v_add_f32 v218, 1.0, v218
    v_rcp_f32 v218, v218
    s_nop 0
    v_mul_f32 v207, v207, v218
    v_cvt_pk_bf16_f32 v26, v204, v205
    v_cvt_pk_bf16_f32 v27, v206, v207
    s_nop 0
    v_permlane16_swap_b32 v24, v26
    v_permlane16_swap_b32 v25, v27
    buffer_store_dwordx4 v[24:27], v14, s[52:55], 0 offen offset:128 sc1
    v_mul_f32 v212, v208, v208
    v_mov_b32 v213, 0xc0135761
    v_fmac_f32 v213, 0xbdd2d3e8, v212
    v_mul_f32 v212, v213, v208
    v_exp_f32 v212, v212
    s_nop 0
    v_add_f32 v212, 1.0, v212
    v_rcp_f32 v212, v212
    s_nop 0
    v_mul_f32 v208, v208, v212
    v_mul_f32 v214, v209, v209
    v_mov_b32 v215, 0xc0135761
    v_fmac_f32 v215, 0xbdd2d3e8, v214
    v_mul_f32 v214, v215, v209
    v_exp_f32 v214, v214
    s_nop 0
    v_add_f32 v214, 1.0, v214
    v_rcp_f32 v214, v214
    s_nop 0
    v_mul_f32 v209, v209, v214
    v_mul_f32 v216, v210, v210
    v_mov_b32 v217, 0xc0135761
    v_fmac_f32 v217, 0xbdd2d3e8, v216
    v_mul_f32 v216, v217, v210
    v_exp_f32 v216, v216
    s_nop 0
    v_add_f32 v216, 1.0, v216
    v_rcp_f32 v216, v216
    s_nop 0
    v_mul_f32 v210, v210, v216
    v_mul_f32 v218, v211, v211
    v_mov_b32 v219, 0xc0135761
    v_fmac_f32 v219, 0xbdd2d3e8, v218
    v_mul_f32 v218, v219, v211
    v_exp_f32 v218, v218
    s_nop 0
    v_add_f32 v218, 1.0, v218
    v_rcp_f32 v218, v218
    s_nop 0
    v_mul_f32 v211, v211, v218
    v_cvt_pk_bf16_f32 v28, v208, v209
    v_cvt_pk_bf16_f32 v29, v210, v211
    buffer_store_dwordx2 v[28:29], v13, s[52:55], 0 offen offset:192 sc1
    s_lshl_b32 s62, s3, 1
    s_add_u32 s63, s62, 1
    s_waitcnt vmcnt(0) lgkmcnt(0)
    s_barrier
    s_cmp_lg_u32 s5, 0
    s_cbranch_scc1 L_sig_44
    v_mov_b32 v8, s62
    v_mov_b32 v9, s63
    v_cmp_eq_u32 vcc, 1, v1
    s_nop 1
    v_cndmask_b32 v8, v8, v9, vcc
    s_lshl_b32 s10, s64, 3
    s_add_u32 s10, s10, 5
    s_lshl_b32 s10, s10, 12
    s_lshl_b32 s11, s4, 3
    s_add_u32 s10, s10, s11
    v_lshlrev_b32 v8, 7, v8
    v_add_u32 v8, s10, v8
    v_mov_b32 v10, s90
    v_mov_b32 v11, s91
    s_mov_b64 exec, 3
    buffer_store_dwordx2 v[10:11], v8, s[92:95], 0 offen sc1
    s_mov_b64 exec, -1
L_sig_44:
    s_cmp_eq_u32 s74, 0
    s_cbranch_scc1 L_skipB_45
    s_lshl_b32 s8, s6, 6
    s_lshr_b32 s9, s5, 1
    s_lshl_b32 s9, s9, 4
    s_add_u32 s8, s8, s9
    v_add_u32 v7, s8, v2
    s_and_b32 s13, s5, 1
    s_mov_b32 s40, s32
    s_mov_b32 s41, s33
    s_mov_b32 s42, 0x188000
    s_mov_b32 s43, 0x00020000
    s_add_u32 s44, s66, 0x1000000
    s_addc_u32 s45, s67, 0
    s_mov_b32 s46, 0x700000
    s_mov_b32 s47, 0x00020000
    s_add_u32 s48, s66, 0x800000
    s_addc_u32 s49, s67, 0
    s_mov_b32 s50, 0x1c0000
    s_mov_b32 s51, 0x00020000
    s_add_u32 s56, s66, 0xc00000
    s_addc_u32 s57, s67, 0
    s_mov_b32 s58, 0x1c0000
    s_mov_b32 s59, 0x00020000
    s_mov_b32 s52, s70
    s_mov_b32 s53, s71
    s_mov_b32 s54, 0x1c0000
    s_mov_b32 s55, 0x00020000
    v_lshrrev_b32 v16, 3, v1
    s_lshl_b32 s10, s5, 3
    v_add_u32 v16, s10, v16
    v_mul_u32_u24 v16, 896, v16
    v_bfe_u32 v9, v1, 4, 1
    s_and_b32 s10, s5, 1
    s_lshl_b32 s10, s10, 1
    v_or_b32 v9, s10, v9
    v_bfe_u32 v10, v1, 1, 2
    v_xor_b32 v9, v9, v10
    v_lshlrev_b32 v9, 5, v9
    v_and_b32 v10, 1, v1
    v_lshlrev_b32 v10, 4, v10
    v_add3_u32 v16, v16, v9, v10
    s_lshl_b32 s10, s7, 7
    v_add_u32 v16, s10, v16
    s_lshl_b32 s10, s5, 2
    v_add_u32 v17, s10, v3
    v_and_b32 v10, 15, v17
    v_xor_b32 v9, v2, v10
    v_lshlrev_b32 v9, 4, v9
    s_lshl_b32 s10, s6, 6
    v_add_u32 v17, s10, v17
    s_mov_b32 s10, 3584
    v_mul_lo_u32 v17, v17, s10
    v_add_u32 v17, v17, v9
    s_lshl_b32 s12, s5, 10
    s_add_u32 m0, s12, 65536
    s_mov_b32 s10, 0
    buffer_load_dwordx4 v16, s[40:43], s10 offen lds
    s_add_u32 m0, s12, 73728
    s_mov_b32 s10, 57344
    buffer_load_dwordx4 v16, s[40:43], s10 offen lds
    s_add_u32 m0, s12, 81920
    s_mov_b32 s10, 114688
    buffer_load_dwordx4 v16, s[40:43], s10 offen lds
    s_add_u32 m0, s12, 90112
    s_mov_b32 s10, 172032
    buffer_load_dwordx4 v16, s[40:43], s10 offen lds
    s_add_u32 m0, s12, 98304
    s_mov_b32 s10, 229376
    buffer_load_dwordx4 v16, s[40:43], s10 offen lds
    s_add_u32 m0, s12, 106496
    s_mov_b32 s10, 286720
    buffer_load_dwordx4 v16, s[40:43], s10 offen lds
    s_cmp_lg_u32 s5, 0
    s_cbranch_scc1 L_wd_46
    v_mov_b32 v8, s6
    s_lshl_b32 s10, s64, 3
    s_add_u32 s10, s10, 5
    s_lshl_b32 s10, s10, 12
    v_lshlrev_b32 v8, 7, v8
    v_lshl_add_u32 v8, v2, 3, v8
    v_add_u32 v8, s10, v8
    s_mov_b32 exec_lo, 0xffff
    s_mov_b32 exec_hi, 0x0
    s_mov_b32 s15, 0
    s_nop 5
L_poll_47:
    buffer_load_dwordx2 v[10:11], v8, s[92:95], 0 offen sc1
    s_waitcnt vmcnt(0)
    v_cmp_ne_u64 vcc, s[90:91], v[10:11]
    s_add_u32 s15, s15, 1
    s_cmp_gt_u32 s15, 0x40000
    s_cbranch_scc1 L_abort
    s_cmp_eq_u64 vcc, 0
    s_nop 2
    s_cbranch_scc1 L_poll_47_done
    s_sleep 1
    s_branch L_poll_47
L_poll_47_done:
    s_mov_b64 exec, -1
L_wd_46:
    s_barrier
    s_add_u32 m0, s12, 0
    s_mov_b32 s10, 0
    buffer_load_dwordx4 v17, s[44:47], s10 offen lds
    s_add_u32 m0, s12, 8192
    s_mov_b32 s10, 114688
    buffer_load_dwordx4 v17, s[44:47], s10 offen lds
    s_add_u32 m0, s12, 16384
    s_mov_b32 s10, 256
    buffer_load_dwordx4 v17, s[44:47], s10 offen lds
    s_add_u32 m0, s12, 24576
    s_mov_b32 s10, 114944
    buffer_load_dwordx4 v17, s[44:47], s10 offen lds
    s_add_u32 m0, s12, 32768
    s_mov_b32 s10, 512
    buffer_load_dwordx4 v17, s[44:47], s10 offen lds
    s_add_u32 m0, s12, 40960
    s_mov_b32 s10, 115200
    buffer_load_dwordx4 v17, s[44:47], s10 offen lds
    s_mov_b32 s10, 896
    v_mul_lo_u32 v13, v7, s10
    s_lshl_b32 s10, s7, 7
    s_lshl_b32 s11, s13, 6
    s_add_u32 s10, s10, s11
    v_lshlrev_b32 v14, 3, v3
    v_add3_u32 v13, v13, v14, s10
    v_lshl_add_u32 v18, v3, 3, v4
    v_lshlrev_b32 v18, 7, v18
    v_lshl_add_u32 v18, v5, 3, v18
    v_add_u32 v18, 65536, v18
    v_lshrrev_b32 v20, 1, v4
    v_and_b32 v21, 1, v3
    v_lshl_or_b32 v20, v21, 1, v20
    s_lshl_b32 s10, s13, 1
    v_xor_b32 v21, s10, v20
    v_lshl_add_u32 v19, v21, 5, v18
    v_xor_b32 v21, 1, v21
    v_lshl_add_u32 v21, v21, 5, v18
    v_mov_b32 v18, v19
    v_mov_b32 v19, v21
    s_lshr_b32 s10, s5, 1
    s_lshl_b32 s10, s10, 12
    v_lshlrev_b32 v24, 8, v2
    v_add_u32 v24, s10, v24
    v_xor_b32 v25, v3, v2
    v_xor_b32 v26, 0, v25
    v_lshl_add_u32 v26, v26, 4, v24
    v_xor_b32 v27, 4, v25
    v_lshl_add_u32 v27, v27, 4, v24
    v_xor_b32 v28, 8, v25
    v_lshl_add_u32 v28, v28, 4, v24
    v_xor_b32 v29, 12, v25
    v_lshl_add_u32 v29, v29, 4, v24
    v_mov_b32 v184, 0
    v_mov_b32 v185, 0
    v_mov_b32 v186, 0
    v_mov_b32 v187, 0
    v_mov_b32 v188, 0
    v_mov_b32 v189, 0
    v_mov_b32 v190, 0
    v_mov_b32 v191, 0
    s_waitcnt vmcnt(4)
    s_barrier
    ds_read_b128 v[160:163], v26 offset:0
    ds_read_b64_tr_b16 v[128:129], v18 offset:0
    ds_read_b64_tr_b16 v[130:131], v18 offset:512
    ds_read_b64_tr_b16 v[132:133], v19 offset:0
    ds_read_b64_tr_b16 v[134:135], v19 offset:512
    ds_read_b128 v[164:167], v27 offset:0
    ds_read_b64_tr_b16 v[136:137], v18 offset:4096
    ds_read_b64_tr_b16 v[138:139], v18 offset:4608
    ds_read_b64_tr_b16 v[140:141], v19 offset:4096
    ds_read_b64_tr_b16 v[142:143], v19 offset:4608
    ds_read_b128 v[168:171], v28 offset:0
    ds_read_b64_tr_b16 v[144:145], v18 offset:8192
    ds_read_b64_tr_b16 v[146:147], v18 offset:8704
    ds_read_b64_tr_b16 v[148:149], v19 offset:8192
    ds_read_b64_tr_b16 v[150:151], v19 offset:8704
    s_add_u32 m0, s12, 114688
    s_mov_b32 s10, 344064
    buffer_load_dwordx4 v16, s[40:43], s10 offen lds
    s_add_u32 m0, s12, 122880
    s_mov_b32 s10, 401408
    buffer_load_dwordx4 v16, s[40:43], s10 offen lds
    s_add_u32 m0, s12, 49152
    s_mov_b32 s10, 768
    buffer_load_dwordx4 v17, s[44:47], s10 offen lds
    s_add_u32 m0, s12, 57344
    s_mov_b32 s10, 115456
    buffer_load_dwordx4 v17, s[44:47], s10 offen lds
    s_waitcnt lgkmcnt(10)
    v_mfma_f32_16x16x32_bf16 v[184:187], v[128:131], v[160:163], v[184:187]
    v_mfma_f32_16x16x32_bf16 v[188:191], v[132:135], v[160:163], v[188:191]
    ds_read_b128 v[160:163], v29 offset:0
    ds_read_b64_tr_b16 v[128:129], v18 offset:12288
    ds_read_b64_tr_b16 v[130:131], v18 offset:12800
    ds_read_b64_tr_b16 v[132:133], v19 offset:12288
    ds_read_b64_tr_b16 v[134:135], v19 offset:12800
    s_waitcnt lgkmcnt(10)
    v_mfma_f32_16x16x32_bf16 v[184:187], v[136:139], v[164:167], v[184:187]
    v_mfma_f32_16x16x32_bf16 v[188:191], v[140:143], v[164:167], v[188:191]
    s_waitcnt lgkmcnt(5)
    v_mfma_f32_16x16x32_bf16 v[184:187], v[144:147], v[168:171], v[184:187]
    v_mfma_f32_16x16x32_bf16 v[188:191], v[148:151], v[168:171], v[188:191]
    s_waitcnt lgkmcnt(0)
    v_mfma_f32_16x16x32_bf16 v[184:187], v[128:131], v[160:163], v[184:187]
    v_mfma_f32_16x16x32_bf16 v[188:191], v[132:135], v[160:163], v[188:191]
    s_waitcnt vmcnt(6)
    s_barrier
    ds_read_b128 v[160:163], v26 offset:16384
    ds_read_b64_tr_b16 v[128:129], v18 offset:16384
    ds_read_b64_tr_b16 v[130:131], v18 offset:16896
    ds_read_b64_tr_b16 v[132:133], v19 offset:16384
    ds_read_b64_tr_b16 v[134:135], v19 offset:16896
    ds_read_b128 v[164:167], v27 offset:16384
    ds_read_b64_tr_b16 v[136:137], v18 offset:20480
    ds_read_b64_tr_b16 v[138:139], v18 offset:20992
    ds_read_b64_tr_b16 v[140:141], v19 offset:20480
    ds_read_b64_tr_b16 v[142:143], v19 offset:20992
    ds_read_b128 v[168:171], v28 offset:16384
    ds_read_b64_tr_b16 v[144:145], v18 offset:24576
    ds_read_b64_tr_b16 v[146:147], v18 offset:25088
    ds_read_b64_tr_b16 v[148:149], v19 offset:24576
    ds_read_b64_tr_b16 v[150:151], v19 offset:25088
    s_add_u32 m0, s12, 65536
    s_mov_b32 s10, 458752
    buffer_load_dwordx4 v16, s[40:43], s10 offen lds
    s_add_u32 m0, s12, 73728
    s_mov_b32 s10, 516096
    buffer_load_dwordx4 v16, s[40:43], s10 offen lds
    s_add_u32 m0, s12, 0
    s_mov_b32 s10, 1024
    buffer_load_dwordx4 v17, s[44:47], s10 offen lds
    s_add_u32 m0, s12, 8192
    s_mov_b32 s10, 115712
    buffer_load_dwordx4 v17, s[44:47], s10 offen lds
    s_waitcnt lgkmcnt(10)
    v_mfma_f32_16x16x32_bf16 v[184:187], v[128:131], v[160:163], v[184:187]
    v_mfma_f32_16x16x32_bf16 v[188:191], v[132:135], v[160:163], v[188:191]
    ds_read_b128 v[160:163], v29 offset:16384
    ds_read_b64_tr_b16 v[128:129], v18 offset:28672
    ds_read_b64_tr_b16 v[130:131], v18 offset:29184
    ds_read_b64_tr_b16 v[132:133], v19 offset:28672
    ds_read_b64_tr_b16 v[134:135], v19 offset:29184
    s_waitcnt lgkmcnt(10)
    v_mfma_f32_16x16x32_bf16 v[184:187], v[136:139], v[164:167], v[184:187]
    v_mfma_f32_16x16x32_bf16 v[188:191], v[140:143], v[164:167], v[188:191]
    s_waitcnt lgkmcnt(5)
    v_mfma_f32_16x16x32_bf16 v[184:187], v[144:147], v[168:171], v[184:187]
    v_mfma_f32_16x16x32_bf16 v[188:191], v[148:151], v[168:171], v[188:191]
    s_waitcnt lgkmcnt(0)
    v_mfma_f32_16x16x32_bf16 v[184:187], v[128:131], v[160:163], v[184:187]
    v_mfma_f32_16x16x32_bf16 v[188:191], v[132:135], v[160:163], v[188:191]
    s_waitcnt vmcnt(8)
    s_barrier
    ds_read_b128 v[160:163], v26 offset:32768
    ds_read_b64_tr_b16 v[128:129], v18 offset:32768
    ds_read_b64_tr_b16 v[130:131], v18 offset:33280
    ds_read_b64_tr_b16 v[132:133], v19 offset:32768
    ds_read_b64_tr_b16 v[134:135], v19 offset:33280
    ds_read_b128 v[164:167], v27 offset:32768
    ds_read_b64_tr_b16 v[136:137], v18 offset:36864
    ds_read_b64_tr_b16 v[138:139], v18 offset:37376
    ds_read_b64_tr_b16 v[140:141], v19 offset:36864
    ds_read_b64_tr_b16 v[142:143], v19 offset:37376
    ds_read_b128 v[168:171], v28 offset:32768
    ds_read_b64_tr_b16 v[144:145], v18 offset:40960
    ds_read_b64_tr_b16 v[146:147], v18 offset:41472
    ds_read_b64_tr_b16 v[148:149], v19 offset:40960
    ds_read_b64_tr_b16 v[150:151], v19 offset:41472
    s_add_u32 m0, s12, 81920
    s_mov_b32 s10, 573440
    buffer_load_dwordx4 v16, s[40:43], s10 offen lds
    s_add_u32 m0, s12, 90112
    s_mov_b32 s10, 630784
    buffer_load_dwordx4 v16, s[40:43], s10 offen lds
    s_add_u32 m0, s12, 16384
    s_mov_b32 s10, 1280
    buffer_load_dwordx4 v17, s[44:47], s10 offen lds
    s_add_u32 m0, s12, 24576
    s_mov_b32 s10, 115968
    buffer_load_dwordx4 v17, s[44:47], s10 offen lds
    s_waitcnt lgkmcnt(10)
    v_mfma_f32_16x16x32_bf16 v[184:187], v[128:131], v[160:163], v[184:187]
    v_mfma_f32_16x16x32_bf16 v[188:191], v[132:135], v[160:163], v[188:191]
    ds_read_b128 v[160:163], v29 offset:32768
    ds_read_b64_tr_b16 v[128:129], v18 offset:45056
    ds_read_b64_tr_b16 v[130:131], v18 offset:45568
    ds_read_b64_tr_b16 v[132:133], v19 offset:45056
    ds_read_b64_tr_b16 v[134:135], v19 offset:45568
    s_waitcnt lgkmcnt(10)
    v_mfma_f32_16x16x32_bf16 v[184:187], v[136:139], v[164:167], v[184:187]
    v_mfma_f32_16x16x32_bf16 v[188:191], v[140:143], v[164:167], v[188:191]
    s_waitcnt lgkmcnt(5)
    v_mfma_f32_16x16x32_bf16 v[184:187], v[144:147], v[168:171], v[184:187]
    v_mfma_f32_16x16x32_bf16 v[188:191], v[148:151], v[168:171], v[188:191]
    s_waitcnt lgkmcnt(0)
    v_mfma_f32_16x16x32_bf16 v[184:187], v[128:131], v[160:163], v[184:187]
    v_mfma_f32_16x16x32_bf16 v[188:191], v[132:135], v[160:163], v[188:191]
    s_waitcnt vmcnt(8)
    s_barrier
    ds_read_b128 v[160:163], v26 offset:49152
    ds_read_b64_tr_b16 v[128:129], v18 offset:49152
    ds_read_b64_tr_b16 v[130:131], v18 offset:49664
    ds_read_b64_tr_b16 v[132:133], v19 offset:49152
    ds_read_b64_tr_b16 v[134:135], v19 offset:49664
    ds_read_b128 v[164:167], v27 offset:49152
    ds_read_b64_tr_b16 v[136:137], v18 offset:53248
    ds_read_b64_tr_b16 v[138:139], v18 offset:53760
    ds_read_b64_tr_b16 v[140:141], v19 offset:53248
    ds_read_b64_tr_b16 v[142:143], v19 offset:53760
    ds_read_b128 v[168:171], v28 offset:49152
    ds_read_b64_tr_b16 v[144:145], v18 offset:57344
    ds_read_b64_tr_b16 v[146:147], v18 offset:57856
    ds_read_b64_tr_b16 v[148:149], v19 offset:57344
    ds_read_b64_tr_b16 v[150:151], v19 offset:57856
    s_add_u32 m0, s12, 98304
    s_mov_b32 s10, 688128
    buffer_load_dwordx4 v16, s[40:43], s10 offen lds
    s_add_u32 m0, s12, 106496
    s_mov_b32 s10, 745472
    buffer_load_dwordx4 v16, s[40:43], s10 offen lds
    s_add_u32 m0, s12, 32768
    s_mov_b32 s10, 1536
    buffer_load_dwordx4 v17, s[44:47], s10 offen lds
    s_add_u32 m0, s12, 40960
    s_mov_b32 s10, 116224
    buffer_load_dwordx4 v17, s[44:47], s10 offen lds
    s_waitcnt lgkmcnt(10)
    v_mfma_f32_16x16x32_bf16 v[184:187], v[128:131], v[160:163], v[184:187]
    v_mfma_f32_16x16x32_bf16 v[188:191], v[132:135], v[160:163], v[188:191]
    ds_read_b128 v[160:163], v29 offset:49152
    ds_read_b64_tr_b16 v[128:129], v18 offset:61440
    ds_read_b64_tr_b16 v[130:131], v18 offset:61952
    ds_read_b64_tr_b16 v[132:133], v19 offset:61440
    ds_read_b64_tr_b16 v[134:135], v19 offset:61952
    s_waitcnt lgkmcnt(10)
    v_mfma_f32_16x16x32_bf16 v[184:187], v[136:139], v[164:167], v[184:187]
    v_mfma_f32_16x16x32_bf16 v[188:191], v[140:143], v[164:167], v[188:191]
    s_waitcnt lgkmcnt(5)
    v_mfma_f32_16x16x32_bf16 v[184:187], v[144:147], v[168:171], v[184:187]
    v_mfma_f32_16x16x32_bf16 v[188:191], v[148:151], v[168:171], v[188:191]
    s_waitcnt lgkmcnt(0)
    v_mfma_f32_16x16x32_bf16 v[184:187], v[128:131], v[160:163], v[184:187]
    v_mfma_f32_16x16x32_bf16 v[188:191], v[132:135], v[160:163], v[188:191]
    s_waitcnt vmcnt(8)
    s_barrier
    ds_read_b128 v[160:163], v26 offset:0
    ds_read_b64_tr_b16 v[128:129], v18 offset:0
    ds_read_b64_tr_b16 v[130:131], v18 offset:512
    ds_read_b64_tr_b16 v[132:133], v19 offset:0
    ds_read_b64_tr_b16 v[134:135], v19 offset:512
    ds_read_b128 v[164:167], v27 offset:0
    ds_read_b64_tr_b16 v[136:137], v18 offset:4096
    ds_read_b64_tr_b16 v[138:139], v18 offset:4608
    ds_read_b64_tr_b16 v[140:141], v19 offset:4096
    ds_read_b64_tr_b16 v[142:143], v19 offset:4608
    ds_read_b128 v[168:171], v28 offset:0
    ds_read_b64_tr_b16 v[144:145], v18 offset:8192
    ds_read_b64_tr_b16 v[146:147], v18 offset:8704
    ds_read_b64_tr_b16 v[148:149], v19 offset:8192
    ds_read_b64_tr_b16 v[150:151], v19 offset:8704
    s_add_u32 m0, s12, 114688
    s_mov_b32 s10, 802816
    buffer_load_dwordx4 v16, s[40:43], s10 offen lds
    s_add_u32 m0, s12, 122880
    s_mov_b32 s10, 860160
    buffer_load_dwordx4 v16, s[40:43], s10 offen lds
    s_add_u32 m0, s12, 49152
    s_mov_b32 s10, 1792
    buffer_load_dwordx4 v17, s[44:47], s10 offen lds
    s_add_u32 m0, s12, 57344
    s_mov_b32 s10, 116480
    buffer_load_dwordx4 v17, s[44:47], s10 offen lds
    s_waitcnt lgkmcnt(10)
    v_mfma_f32_16x16x32_bf16 v[184:187], v[128:131], v[160:163], v[184:187]
    v_mfma_f32_16x16x32_bf16 v[188:191], v[132:135], v[160:163], v[188:191]
    ds_read_b128 v[160:163], v29 offset:0
    ds_read_b64_tr_b16 v[128:129], v18 offset:12288
    ds_read_b64_tr_b16 v[130:131], v18 offset:12800
    ds_read_b64_tr_b16 v[132:133], v19 offset:12288
    ds_read_b64_tr_b16 v[134:135], v19 offset:12800
    s_waitcnt lgkmcnt(10)
    v_mfma_f32_16x16x32_bf16 v[184:187], v[136:139], v[164:167], v[184:187]
    v_mfma_f32_16x16x32_bf16 v[188:191], v[140:143], v[164:167], v[188:191]
    s_waitcnt lgkmcnt(5)
    v_mfma_f32_16x16x32_bf16 v[184:187], v[144:147], v[168:171], v[184:187]
    v_mfma_f32_16x16x32_bf16 v[188:191], v[148:151], v[168:171], v[188:191]
    s_waitcnt lgkmcnt(0)
    v_mfma_f32_16x16x32_bf16 v[184:187], v[128:131], v[160:163], v[184:187]
    v_mfma_f32_16x16x32_bf16 v[188:191], v[132:135], v[160:163], v[188:191]
    s_waitcnt vmcnt(8)
    s_barrier
    ds_read_b128 v[160:163], v26 offset:16384
    ds_read_b64_tr_b16 v[128:129], v18 offset:16384
    ds_read_b64_tr_b16 v[130:131], v18 offset:16896
    ds_read_b64_tr_b16 v[132:133], v19 offset:16384
    ds_read_b64_tr_b16 v[134:135], v19 offset:16896
    ds_read_b128 v[164:167], v27 offset:16384
    ds_read_b64_tr_b16 v[136:137], v18 offset:20480
    ds_read_b64_tr_b16 v[138:139], v18 offset:20992
    ds_read_b64_tr_b16 v[140:141], v19 offset:20480
    ds_read_b64_tr_b16 v[142:143], v19 offset:20992
    ds_read_b128 v[168:171], v28 offset:16384
    ds_read_b64_tr_b16 v[144:145], v18 offset:24576
    ds_read_b64_tr_b16 v[146:147], v18 offset:25088
    ds_read_b64_tr_b16 v[148:149], v19 offset:24576
    ds_read_b64_tr_b16 v[150:151], v19 offset:25088
    s_add_u32 m0, s12, 65536
    s_mov_b32 s10, 917504
    buffer_load_dwordx4 v16, s[40:43], s10 offen lds
    s_add_u32 m0, s12, 73728
    s_mov_b32 s10, 974848
    buffer_load_dwordx4 v16, s[40:43], s10 offen lds
    s_add_u32 m0, s12, 0
    s_mov_b32 s10, 2048
    buffer_load_dwordx4 v17, s[44:47], s10 offen lds
    s_add_u32 m0, s12, 8192
    s_mov_b32 s10, 116736
    buffer_load_dwordx4 v17, s[44:47], s10 offen lds
    s_waitcnt lgkmcnt(10)
    v_mfma_f32_16x16x32_bf16 v[184:187], v[128:131], v[160:163], v[184:187]
    v_mfma_f32_16x16x32_bf16 v[188:191], v[132:135], v[160:163], v[188:191]
    ds_read_b128 v[160:163], v29 offset:16384
    ds_read_b64_tr_b16 v[128:129], v18 offset:28672
    ds_read_b64_tr_b16 v[130:131], v18 offset:29184
    ds_read_b64_tr_b16 v[132:133], v19 offset:28672
    ds_read_b64_tr_b16 v[134:135], v19 offset:29184
    s_waitcnt lgkmcnt(10)
    v_mfma_f32_16x16x32_bf16 v[184:187], v[136:139], v[164:167], v[184:187]
    v_mfma_f32_16x16x32_bf16 v[188:191], v[140:143], v[164:167], v[188:191]
    s_waitcnt lgkmcnt(5)
    v_mfma_f32_16x16x32_bf16 v[184:187], v[144:147], v[168:171], v[184:187]
    v_mfma_f32_16x16x32_bf16 v[188:191], v[148:151], v[168:171], v[188:191]
    s_waitcnt lgkmcnt(0)
    v_mfma_f32_16x16x32_bf16 v[184:187], v[128:131], v[160:163], v[184:187]
    v_mfma_f32_16x16x32_bf16 v[188:191], v[132:135], v[160:163], v[188:191]
    s_waitcnt vmcnt(8)
    s_barrier
    ds_read_b128 v[160:163], v26 offset:32768
    ds_read_b64_tr_b16 v[128:129], v18 offset:32768
    ds_read_b64_tr_b16 v[130:131], v18 offset:33280
    ds_read_b64_tr_b16 v[132:133], v19 offset:32768
    ds_read_b64_tr_b16 v[134:135], v19 offset:33280
    ds_read_b128 v[164:167], v27 offset:32768
    ds_read_b64_tr_b16 v[136:137], v18 offset:36864
    ds_read_b64_tr_b16 v[138:139], v18 offset:37376
    ds_read_b64_tr_b16 v[140:141], v19 offset:36864
    ds_read_b64_tr_b16 v[142:143], v19 offset:37376
    ds_read_b128 v[168:171], v28 offset:32768
    ds_read_b64_tr_b16 v[144:145], v18 offset:40960
    ds_read_b64_tr_b16 v[146:147], v18 offset:41472
    ds_read_b64_tr_b16 v[148:149], v19 offset:40960
    ds_read_b64_tr_b16 v[150:151], v19 offset:41472
    s_add_u32 m0, s12, 81920
    s_mov_b32 s10, 1032192
    buffer_load_dwordx4 v16, s[40:43], s10 offen lds
    s_add_u32 m0, s12, 90112
    s_mov_b32 s10, 1089536
    buffer_load_dwordx4 v16, s[40:43], s10 offen lds
    s_add_u32 m0, s12, 16384
    s_mov_b32 s10, 2304
    buffer_load_dwordx4 v17, s[44:47], s10 offen lds
    s_add_u32 m0, s12, 24576
    s_mov_b32 s10, 116992
    buffer_load_dwordx4 v17, s[44:47], s10 offen lds
    s_waitcnt lgkmcnt(10)
    v_mfma_f32_16x16x32_bf16 v[184:187], v[128:131], v[160:163], v[184:187]
    v_mfma_f32_16x16x32_bf16 v[188:191], v[132:135], v[160:163], v[188:191]
    ds_read_b128 v[160:163], v29 offset:32768
    ds_read_b64_tr_b16 v[128:129], v18 offset:45056
    ds_read_b64_tr_b16 v[130:131], v18 offset:45568
    ds_read_b64_tr_b16 v[132:133], v19 offset:45056
    ds_read_b64_tr_b16 v[134:135], v19 offset:45568
    s_waitcnt lgkmcnt(10)
    v_mfma_f32_16x16x32_bf16 v[184:187], v[136:139], v[164:167], v[184:187]
    v_mfma_f32_16x16x32_bf16 v[188:191], v[140:143], v[164:167], v[188:191]
    s_waitcnt lgkmcnt(5)
    v_mfma_f32_16x16x32_bf16 v[184:187], v[144:147], v[168:171], v[184:187]
    v_mfma_f32_16x16x32_bf16 v[188:191], v[148:151], v[168:171], v[188:191]
    s_waitcnt lgkmcnt(0)
    v_mfma_f32_16x16x32_bf16 v[184:187], v[128:131], v[160:163], v[184:187]
    v_mfma_f32_16x16x32_bf16 v[188:191], v[132:135], v[160:163], v[188:191]
    s_waitcnt vmcnt(8)
    s_barrier
    ds_read_b128 v[160:163], v26 offset:49152
    ds_read_b64_tr_b16 v[128:129], v18 offset:49152
    ds_read_b64_tr_b16 v[130:131], v18 offset:49664
    ds_read_b64_tr_b16 v[132:133], v19 offset:49152
    ds_read_b64_tr_b16 v[134:135], v19 offset:49664
    ds_read_b128 v[164:167], v27 offset:49152
    ds_read_b64_tr_b16 v[136:137], v18 offset:53248
    ds_read_b64_tr_b16 v[138:139], v18 offset:53760
    ds_read_b64_tr_b16 v[140:141], v19 offset:53248
    ds_read_b64_tr_b16 v[142:143], v19 offset:53760
    ds_read_b128 v[168:171], v28 offset:49152
    ds_read_b64_tr_b16 v[144:145], v18 offset:57344
    ds_read_b64_tr_b16 v[146:147], v18 offset:57856
    ds_read_b64_tr_b16 v[148:149], v19 offset:57344
    ds_read_b64_tr_b16 v[150:151], v19 offset:57856
    s_add_u32 m0, s12, 98304
    s_mov_b32 s10, 1146880
    buffer_load_dwordx4 v16, s[40:43], s10 offen lds
    s_add_u32 m0, s12, 106496
    s_mov_b32 s10, 1204224
    buffer_load_dwordx4 v16, s[40:43], s10 offen lds
    s_add_u32 m0, s12, 32768
    s_mov_b32 s10, 2560
    buffer_load_dwordx4 v17, s[44:47], s10 offen lds
    s_add_u32 m0, s12, 40960
    s_mov_b32 s10, 117248
    buffer_load_dwordx4 v17, s[44:47], s10 offen lds
    s_waitcnt lgkmcnt(10)
    v_mfma_f32_16x16x32_bf16 v[184:187], v[128:131], v[160:163], v[184:187]
    v_mfma_f32_16x16x32_bf16 v[188:191], v[132:135], v[160:163], v[188:191]
    ds_read_b128 v[160:163], v29 offset:49152
    ds_read_b64_tr_b16 v[128:129], v18 offset:61440
    ds_read_b64_tr_b16 v[130:131], v18 offset:61952
    ds_read_b64_tr_b16 v[132:133], v19 offset:61440
    ds_read_b64_tr_b16 v[134:135], v19 offset:61952
    s_waitcnt lgkmcnt(10)
    v_mfma_f32_16x16x32_bf16 v[184:187], v[136:139], v[164:167], v[184:187]
    v_mfma_f32_16x16x32_bf16 v[188:191], v[140:143], v[164:167], v[188:191]
    s_waitcnt lgkmcnt(5)
    v_mfma_f32_16x16x32_bf16 v[184:187], v[144:147], v[168:171], v[184:187]
    v_mfma_f32_16x16x32_bf16 v[188:191], v[148:151], v[168:171], v[188:191]
    s_waitcnt lgkmcnt(0)
    v_mfma_f32_16x16x32_bf16 v[184:187], v[128:131], v[160:163], v[184:187]
    v_mfma_f32_16x16x32_bf16 v[188:191], v[132:135], v[160:163], v[188:191]
    s_waitcnt vmcnt(8)
    s_barrier
    ds_read_b128 v[160:163], v26 offset:0
    ds_read_b64_tr_b16 v[128:129], v18 offset:0
    ds_read_b64_tr_b16 v[130:131], v18 offset:512
    ds_read_b64_tr_b16 v[132:133], v19 offset:0
    ds_read_b64_tr_b16 v[134:135], v19 offset:512
    ds_read_b128 v[164:167], v27 offset:0
    ds_read_b64_tr_b16 v[136:137], v18 offset:4096
    ds_read_b64_tr_b16 v[138:139], v18 offset:4608
    ds_read_b64_tr_b16 v[140:141], v19 offset:4096
    ds_read_b64_tr_b16 v[142:143], v19 offset:4608
    ds_read_b128 v[168:171], v28 offset:0
    ds_read_b64_tr_b16 v[144:145], v18 offset:8192
    ds_read_b64_tr_b16 v[146:147], v18 offset:8704
    ds_read_b64_tr_b16 v[148:149], v19 offset:8192
    ds_read_b64_tr_b16 v[150:151], v19 offset:8704
    s_add_u32 m0, s12, 114688
    s_mov_b32 s10, 1261568
    buffer_load_dwordx4 v16, s[40:43], s10 offen lds
    s_add_u32 m0, s12, 122880
    s_mov_b32 s10, 1318912
    buffer_load_dwordx4 v16, s[40:43], s10 offen lds
    s_add_u32 m0, s12, 49152
    s_mov_b32 s10, 2816
    buffer_load_dwordx4 v17, s[44:47], s10 offen lds
    s_add_u32 m0, s12, 57344
    s_mov_b32 s10, 117504
    buffer_load_dwordx4 v17, s[44:47], s10 offen lds
    s_waitcnt lgkmcnt(10)
    v_mfma_f32_16x16x32_bf16 v[184:187], v[128:131], v[160:163], v[184:187]
    v_mfma_f32_16x16x32_bf16 v[188:191], v[132:135], v[160:163], v[188:191]
    ds_read_b128 v[160:163], v29 offset:0
    ds_read_b64_tr_b16 v[128:129], v18 offset:12288
    ds_read_b64_tr_b16 v[130:131], v18 offset:12800
    ds_read_b64_tr_b16 v[132:133], v19 offset:12288
    ds_read_b64_tr_b16 v[134:135], v19 offset:12800
    s_waitcnt lgkmcnt(10)
    v_mfma_f32_16x16x32_bf16 v[184:187], v[136:139], v[164:167], v[184:187]
    v_mfma_f32_16x16x32_bf16 v[188:191], v[140:143], v[164:167], v[188:191]
    s_waitcnt lgkmcnt(5)
    v_mfma_f32_16x16x32_bf16 v[184:187], v[144:147], v[168:171], v[184:187]
    v_mfma_f32_16x16x32_bf16 v[188:191], v[148:151], v[168:171], v[188:191]
    s_waitcnt lgkmcnt(0)
    v_mfma_f32_16x16x32_bf16 v[184:187], v[128:131], v[160:163], v[184:187]
    v_mfma_f32_16x16x32_bf16 v[188:191], v[132:135], v[160:163], v[188:191]
    s_waitcnt vmcnt(8)
    s_barrier
    ds_read_b128 v[160:163], v26 offset:16384
    ds_read_b64_tr_b16 v[128:129], v18 offset:16384
    ds_read_b64_tr_b16 v[130:131], v18 offset:16896
    ds_read_b64_tr_b16 v[132:133], v19 offset:16384
    ds_read_b64_tr_b16 v[134:135], v19 offset:16896
    ds_read_b128 v[164:167], v27 offset:16384
    ds_read_b64_tr_b16 v[136:137], v18 offset:20480
    ds_read_b64_tr_b16 v[138:139], v18 offset:20992
    ds_read_b64_tr_b16 v[140:141], v19 offset:20480
    ds_read_b64_tr_b16 v[142:143], v19 offset:20992
    ds_read_b128 v[168:171], v28 offset:16384
    ds_read_b64_tr_b16 v[144:145], v18 offset:24576
    ds_read_b64_tr_b16 v[146:147], v18 offset:25088
    ds_read_b64_tr_b16 v[148:149], v19 offset:24576
    ds_read_b64_tr_b16 v[150:151], v19 offset:25088
    s_add_u32 m0, s12, 65536
    s_mov_b32 s10, 1376256
    buffer_load_dwordx4 v16, s[40:43], s10 offen lds
    s_add_u32 m0, s12, 73728
    s_mov_b32 s10, 1433600
    buffer_load_dwordx4 v16, s[40:43], s10 offen lds
    s_add_u32 m0, s12, 0
    s_mov_b32 s10, 3072
    buffer_load_dwordx4 v17, s[44:47], s10 offen lds
    s_add_u32 m0, s12, 8192
    s_mov_b32 s10, 117760
    buffer_load_dwordx4 v17, s[44:47], s10 offen lds
    s_waitcnt lgkmcnt(10)
    v_mfma_f32_16x16x32_bf16 v[184:187], v[128:131], v[160:163], v[184:187]
    v_mfma_f32_16x16x32_bf16 v[188:191], v[132:135], v[160:163], v[188:191]
    ds_read_b128 v[160:163], v29 offset:16384
    ds_read_b64_tr_b16 v[128:129], v18 offset:28672
    ds_read_b64_tr_b16 v[130:131], v18 offset:29184
    ds_read_b64_tr_b16 v[132:133], v19 offset:28672
    ds_read_b64_tr_b16 v[134:135], v19 offset:29184
    s_waitcnt lgkmcnt(10)
    v_mfma_f32_16x16x32_bf16 v[184:187], v[136:139], v[164:167], v[184:187]
    v_mfma_f32_16x16x32_bf16 v[188:191], v[140:143], v[164:167], v[188:191]
    s_waitcnt lgkmcnt(5)
    v_mfma_f32_16x16x32_bf16 v[184:187], v[144:147], v[168:171], v[184:187]
    v_mfma_f32_16x16x32_bf16 v[188:191], v[148:151], v[168:171], v[188:191]
    s_waitcnt lgkmcnt(0)
    v_mfma_f32_16x16x32_bf16 v[184:187], v[128:131], v[160:163], v[184:187]
    v_mfma_f32_16x16x32_bf16 v[188:191], v[132:135], v[160:163], v[188:191]
    s_waitcnt vmcnt(8)
    s_barrier
    ds_read_b128 v[160:163], v26 offset:32768
    ds_read_b64_tr_b16 v[128:129], v18 offset:32768
    ds_read_b64_tr_b16 v[130:131], v18 offset:33280
    ds_read_b64_tr_b16 v[132:133], v19 offset:32768
    ds_read_b64_tr_b16 v[134:135], v19 offset:33280
    ds_read_b128 v[164:167], v27 offset:32768
    ds_read_b64_tr_b16 v[136:137], v18 offset:36864
    ds_read_b64_tr_b16 v[138:139], v18 offset:37376
    ds_read_b64_tr_b16 v[140:141], v19 offset:36864
    ds_read_b64_tr_b16 v[142:143], v19 offset:37376
    ds_read_b128 v[168:171], v28 offset:32768
    ds_read_b64_tr_b16 v[144:145], v18 offset:40960
    ds_read_b64_tr_b16 v[146:147], v18 offset:41472
    ds_read_b64_tr_b16 v[148:149], v19 offset:40960
    ds_read_b64_tr_b16 v[150:151], v19 offset:41472
    s_add_u32 m0, s12, 81920
    s_mov_b32 s10, 1490944
    buffer_load_dwordx4 v16, s[40:43], s10 offen lds
    s_add_u32 m0, s12, 90112
    s_mov_b32 s10, 1548288
    buffer_load_dwordx4 v16, s[40:43], s10 offen lds
    s_add_u32 m0, s12, 16384
    s_mov_b32 s10, 3328
    buffer_load_dwordx4 v17, s[44:47], s10 offen lds
    s_add_u32 m0, s12, 24576
    s_mov_b32 s10, 118016
    buffer_load_dwordx4 v17, s[44:47], s10 offen lds
    s_waitcnt lgkmcnt(10)
    v_mfma_f32_16x16x32_bf16 v[184:187], v[128:131], v[160:163], v[184:187]
    v_mfma_f32_16x16x32_bf16 v[188:191], v[132:135], v[160:163], v[188:191]
    ds_read_b128 v[160:163], v29 offset:32768
    ds_read_b64_tr_b16 v[128:129], v18 offset:45056
    ds_read_b64_tr_b16 v[130:131], v18 offset:45568
    ds_read_b64_tr_b16 v[132:133], v19 offset:45056
    ds_read_b64_tr_b16 v[134:135], v19 offset:45568
    s_waitcnt lgkmcnt(10)
    v_mfma_f32_16x16x32_bf16 v[184:187], v[136:139], v[164:167], v[184:187]
    v_mfma_f32_16x16x32_bf16 v[188:191], v[140:143], v[164:167], v[188:191]
    s_waitcnt lgkmcnt(5)
    v_mfma_f32_16x16x32_bf16 v[184:187], v[144:147], v[168:171], v[184:187]
    v_mfma_f32_16x16x32_bf16 v[188:191], v[148:151], v[168:171], v[188:191]
    s_waitcnt lgkmcnt(0)
    v_mfma_f32_16x16x32_bf16 v[184:187], v[128:131], v[160:163], v[184:187]
    v_mfma_f32_16x16x32_bf16 v[188:191], v[132:135], v[160:163], v[188:191]
    s_cmp_lg_u32 s64, 0
    s_cbranch_scc1 L_s6no_48
    s_mov_b32 s44, s18
    s_mov_b32 s45, s19
    s_mov_b32 s46, 0x126000
    s_mov_b32 s47, 0x00020000
    s_waitcnt vmcnt(8)
    s_barrier
    ds_read_b128 v[160:163], v26 offset:49152
    ds_read_b64_tr_b16 v[128:129], v18 offset:49152
    ds_read_b64_tr_b16 v[130:131], v18 offset:49664
    ds_read_b64_tr_b16 v[132:133], v19 offset:49152
    ds_read_b64_tr_b16 v[134:135], v19 offset:49664
    ds_read_b128 v[164:167], v27 offset:49152
    ds_read_b64_tr_b16 v[136:137], v18 offset:53248
    ds_read_b64_tr_b16 v[138:139], v18 offset:53760
    ds_read_b64_tr_b16 v[140:141], v19 offset:53248
    ds_read_b64_tr_b16 v[142:143], v19 offset:53760
    ds_read_b128 v[168:171], v28 offset:49152
    ds_read_b64_tr_b16 v[144:145], v18 offset:57344
    ds_read_b64_tr_b16 v[146:147], v18 offset:57856
    ds_read_b64_tr_b16 v[148:149], v19 offset:57344
    ds_read_b64_tr_b16 v[150:151], v19 offset:57856
    buffer_load_dwordx2 v[40:41], v13, s[48:51], 0 offen
    buffer_load_dwordx2 v[42:43], v13, s[48:51], 0 offen offset:32
    buffer_load_dwordx2 v[44:45], v13, s[56:59], 0 offen
    buffer_load_dwordx2 v[46:47], v13, s[56:59], 0 offen offset:32
    s_waitcnt lgkmcnt(10)
    v_mfma_f32_16x16x32_bf16 v[184:187], v[128:131], v[160:163], v[184:187]
    v_mfma_f32_16x16x32_bf16 v[188:191], v[132:135], v[160:163], v[188:191]
    ds_read_b128 v[160:163], v29 offset:49152
    ds_read_b64_tr_b16 v[128:129], v18 offset:61440
    ds_read_b64_tr_b16 v[130:131], v18 offset:61952
    ds_read_b64_tr_b16 v[132:133], v19 offset:61440
    ds_read_b64_tr_b16 v[134:135], v19 offset:61952
    s_waitcnt lgkmcnt(10)
    v_mfma_f32_16x16x32_bf16 v[184:187], v[136:139], v[164:167], v[184:187]
    v_mfma_f32_16x16x32_bf16 v[188:191], v[140:143], v[164:167], v[188:191]
    s_waitcnt lgkmcnt(5)
    v_mfma_f32_16x16x32_bf16 v[184:187], v[144:147], v[168:171], v[184:187]
    v_mfma_f32_16x16x32_bf16 v[188:191], v[148:151], v[168:171], v[188:191]
    s_waitcnt lgkmcnt(0)
    v_mfma_f32_16x16x32_bf16 v[184:187], v[128:131], v[160:163], v[184:187]
    v_mfma_f32_16x16x32_bf16 v[188:191], v[132:135], v[160:163], v[188:191]
    s_mul_i32 s11, s4, 56
    s_lshl_b32 s12, s5, 10
    s_add_u32 s12, s12, 65536
    s_lshl_b32 s10, s5, 6
    v_add_u32 v12, s10, v1
    v_add_u32 v8, 2048, v12
    v_mul_u32_u24 v9, 2731, v8
    v_lshrrev_b32 v9, 15, v9
    v_mul_u32_u24 v10, 12, v9
    v_sub_u32 v8, v8, v10
    v_bfe_u32 v10, v9, 3, 1
    v_lshlrev_b32 v10, 1, v10
    v_xor_b32 v8, v8, v10
    s_mov_b32 s10, 2688
    v_mul_lo_u32 v9, v9, s10
    v_lshrrev_b32 v10, 2, v8
    v_mul_u32_u24 v10, 896, v10
    v_and_b32 v8, 3, v8
    v_lshlrev_b32 v8, 4, v8
    v_add3_u32 v9, v9, v10, v8
    s_add_u32 m0, s12, 32768
    s_nop 0
    buffer_load_dwordx4 v9, s[44:47], s11 offen lds
    v_add_u32 v8, 2560, v12
    v_mul_u32_u24 v9, 2731, v8
    v_lshrrev_b32 v9, 15, v9
    v_mul_u32_u24 v10, 12, v9
    v_sub_u32 v8, v8, v10
    v_bfe_u32 v10, v9, 3, 1
    v_lshlrev_b32 v10, 1, v10
    v_xor_b32 v8, v8, v10
    s_mov_b32 s10, 2688
    v_mul_lo_u32 v9, v9, s10
    v_lshrrev_b32 v10, 2, v8
    v_mul_u32_u24 v10, 896, v10
    v_and_b32 v8, 3, v8
    v_lshlrev_b32 v8, 4, v8
    v_add3_u32 v9, v9, v10, v8
    s_add_u32 m0, s12, 40960
    s_nop 0
    buffer_load_dwordx4 v9, s[44:47], s11 offen lds
    v_add_u32 v8, 4096, v12
    v_mul_u32_u24 v9, 2731, v8
    v_lshrrev_b32 v9, 15, v9
    v_mul_u32_u24 v10, 12, v9
    v_sub_u32 v8, v8, v10
    v_bfe_u32 v10, v9, 3, 1
    v_lshlrev_b32 v10, 1, v10
    v_xor_b32 v8, v8, v10
    s_mov_b32 s10, 2688
    v_mul_lo_u32 v9, v9, s10
    v_lshrrev_b32 v10, 2, v8
    v_mul_u32_u24 v10, 896, v10
    v_and_b32 v8, 3, v8
    v_lshlrev_b32 v8, 4, v8
    v_add3_u32 v9, v9, v10, v8
    s_add_u32 m0, s12, 65536
    s_nop 0
    buffer_load_dwordx4 v9, s[44:47], s11 offen lds
    s_lshl_b32 s12, s5, 10
    s_waitcnt vmcnt(11)
    s_barrier
    ds_read_b128 v[160:163], v26 offset:0
    ds_read_b64_tr_b16 v[128:129], v18 offset:0
    ds_read_b64_tr_b16 v[130:131], v18 offset:512
    ds_read_b64_tr_b16 v[132:133], v19 offset:0
    ds_read_b64_tr_b16 v[134:135], v19 offset:512
    ds_read_b128 v[164:167], v27 offset:0
    ds_read_b64_tr_b16 v[136:137], v18 offset:4096
    ds_read_b64_tr_b16 v[138:139], v18 offset:4608
    ds_read_b64_tr_b16 v[140:141], v19 offset:4096
    ds_read_b64_tr_b16 v[142:143], v19 offset:4608
    ds_read_b128 v[168:171], v28 offset:0
    ds_read_b64_tr_b16 v[144:145], v18 offset:8192
    ds_read_b64_tr_b16 v[146:147], v18 offset:8704
    ds_read_b64_tr_b16 v[148:149], v19 offset:8192
    ds_read_b64_tr_b16 v[150:151], v19 offset:8704
    s_waitcnt lgkmcnt(10)
    v_mfma_f32_16x16x32_bf16 v[184:187], v[128:131], v[160:163], v[184:187]
    v_mfma_f32_16x16x32_bf16 v[188:191], v[132:135], v[160:163], v[188:191]
    ds_read_b128 v[160:163], v29 offset:0
    ds_read_b64_tr_b16 v[128:129], v18 offset:12288
    ds_read_b64_tr_b16 v[130:131], v18 offset:12800
    ds_read_b64_tr_b16 v[132:133], v19 offset:12288
    ds_read_b64_tr_b16 v[134:135], v19 offset:12800
    s_waitcnt lgkmcnt(10)
    v_mfma_f32_16x16x32_bf16 v[184:187], v[136:139], v[164:167], v[184:187]
    v_mfma_f32_16x16x32_bf16 v[188:191], v[140:143], v[164:167], v[188:191]
    s_waitcnt lgkmcnt(5)
    v_mfma_f32_16x16x32_bf16 v[184:187], v[144:147], v[168:171], v[184:187]
    v_mfma_f32_16x16x32_bf16 v[188:191], v[148:151], v[168:171], v[188:191]
    s_waitcnt lgkmcnt(0)
    v_mfma_f32_16x16x32_bf16 v[184:187], v[128:131], v[160:163], v[184:187]
    v_mfma_f32_16x16x32_bf16 v[188:191], v[132:135], v[160:163], v[188:191]
    s_mul_i32 s11, s4, 56
    s_lshl_b32 s12, s5, 10
    s_add_u32 s12, s12, 65536
    s_lshl_b32 s10, s5, 6
    v_add_u32 v12, s10, v1
    v_add_u32 v8, 3072, v12
    v_mul_u32_u24 v9, 2731, v8
    v_lshrrev_b32 v9, 15, v9
    v_mul_u32_u24 v10, 12, v9
    v_sub_u32 v8, v8, v10
    v_bfe_u32 v10, v9, 3, 1
    v_lshlrev_b32 v10, 1, v10
    v_xor_b32 v8, v8, v10
    s_mov_b32 s10, 2688
    v_mul_lo_u32 v9, v9, s10
    v_lshrrev_b32 v10, 2, v8
    v_mul_u32_u24 v10, 896, v10
    v_and_b32 v8, 3, v8
    v_lshlrev_b32 v8, 4, v8
    v_add3_u32 v9, v9, v10, v8
    s_add_u32 m0, s12, 49152
    s_nop 0
    buffer_load_dwordx4 v9, s[44:47], s11 offen lds
    v_add_u32 v8, 3584, v12
    v_mul_u32_u24 v9, 2731, v8
    v_lshrrev_b32 v9, 15, v9
    v_mul_u32_u24 v10, 12, v9
    v_sub_u32 v8, v8, v10
    v_bfe_u32 v10, v9, 3, 1
    v_lshlrev_b32 v10, 1, v10
    v_xor_b32 v8, v8, v10
    s_mov_b32 s10, 2688
    v_mul_lo_u32 v9, v9, s10
    v_lshrrev_b32 v10, 2, v8
    v_mul_u32_u24 v10, 896, v10
    v_and_b32 v8, 3, v8
    v_lshlrev_b32 v8, 4, v8
    v_add3_u32 v9, v9, v10, v8
    s_add_u32 m0, s12, 57344
    s_nop 0
    buffer_load_dwordx4 v9, s[44:47], s11 offen lds
    v_add_u32 v8, 4608, v12
    v_mul_u32_u24 v9, 2731, v8
    v_lshrrev_b32 v9, 15, v9
    v_mul_u32_u24 v10, 12, v9
    v_sub_u32 v8, v8, v10
    v_bfe_u32 v10, v9, 3, 1
    v_lshlrev_b32 v10, 1, v10
    v_xor_b32 v8, v8, v10
    s_mov_b32 s10, 2688
    v_mul_lo_u32 v9, v9, s10
    v_lshrrev_b32 v10, 2, v8
    v_mul_u32_u24 v10, 896, v10
    v_and_b32 v8, 3, v8
    v_lshlrev_b32 v8, 4, v8
    v_add3_u32 v9, v9, v10, v8
    s_add_u32 m0, s12, 73728
    s_nop 0
    buffer_load_dwordx4 v9, s[44:47], s11 offen lds
    s_lshl_b32 s12, s5, 10
    s_waitcnt vmcnt(10)
    s_barrier
    ds_read_b128 v[160:163], v26 offset:16384
    ds_read_b64_tr_b16 v[128:129], v18 offset:16384
    ds_read_b64_tr_b16 v[130:131], v18 offset:16896
    ds_read_b64_tr_b16 v[132:133], v19 offset:16384
    ds_read_b64_tr_b16 v[134:135], v19 offset:16896
    ds_read_b128 v[164:167], v27 offset:16384
    ds_read_b64_tr_b16 v[136:137], v18 offset:20480
    ds_read_b64_tr_b16 v[138:139], v18 offset:20992
    ds_read_b64_tr_b16 v[140:141], v19 offset:20480
    ds_read_b64_tr_b16 v[142:143], v19 offset:20992
    ds_read_b128 v[168:171], v28 offset:16384
    ds_read_b64_tr_b16 v[144:145], v18 offset:24576
    ds_read_b64_tr_b16 v[146:147], v18 offset:25088
    ds_read_b64_tr_b16 v[148:149], v19 offset:24576
    ds_read_b64_tr_b16 v[150:151], v19 offset:25088
    s_waitcnt lgkmcnt(10)
    v_mfma_f32_16x16x32_bf16 v[184:187], v[128:131], v[160:163], v[184:187]
    v_mfma_f32_16x16x32_bf16 v[188:191], v[132:135], v[160:163], v[188:191]
    ds_read_b128 v[160:163], v29 offset:16384
    ds_read_b64_tr_b16 v[128:129], v18 offset:28672
    ds_read_b64_tr_b16 v[130:131], v18 offset:29184
    ds_read_b64_tr_b16 v[132:133], v19 offset:28672
    ds_read_b64_tr_b16 v[134:135], v19 offset:29184
    s_waitcnt lgkmcnt(10)
    v_mfma_f32_16x16x32_bf16 v[184:187], v[136:139], v[164:167], v[184:187]
    v_mfma_f32_16x16x32_bf16 v[188:191], v[140:143], v[164:167], v[188:191]
    s_waitcnt lgkmcnt(5)
    v_mfma_f32_16x16x32_bf16 v[184:187], v[144:147], v[168:171], v[184:187]
    v_mfma_f32_16x16x32_bf16 v[188:191], v[148:151], v[168:171], v[188:191]
    s_waitcnt lgkmcnt(0)
    v_mfma_f32_16x16x32_bf16 v[184:187], v[128:131], v[160:163], v[184:187]
    v_mfma_f32_16x16x32_bf16 v[188:191], v[132:135], v[160:163], v[188:191]
    s_mul_i32 s11, s4, 56
    s_lshl_b32 s12, s5, 10
    s_add_u32 s12, s12, 65536
    s_lshl_b32 s10, s5, 6
    v_add_u32 v12, s10, v1
    v_add_u32 v8, 0, v12
    v_mul_u32_u24 v9, 2731, v8
    v_lshrrev_b32 v9, 15, v9
    v_mul_u32_u24 v10, 12, v9
    v_sub_u32 v8, v8, v10
    v_bfe_u32 v10, v9, 3, 1
    v_lshlrev_b32 v10, 1, v10
    v_xor_b32 v8, v8, v10
    s_mov_b32 s10, 2688
    v_mul_lo_u32 v9, v9, s10
    v_lshrrev_b32 v10, 2, v8
    v_mul_u32_u24 v10, 896, v10
    v_and_b32 v8, 3, v8
    v_lshlrev_b32 v8, 4, v8
    v_add3_u32 v9, v9, v10, v8
    s_add_u32 m0, s12, 0
    s_nop 0
    buffer_load_dwordx4 v9, s[44:47], s11 offen lds
    v_add_u32 v8, 512, v12
    v_mul_u32_u24 v9, 2731, v8
    v_lshrrev_b32 v9, 15, v9
    v_mul_u32_u24 v10, 12, v9
    v_sub_u32 v8, v8, v10
    v_bfe_u32 v10, v9, 3, 1
    v_lshlrev_b32 v10, 1, v10
    v_xor_b32 v8, v8, v10
    s_mov_b32 s10, 2688
    v_mul_lo_u32 v9, v9, s10
    v_lshrrev_b32 v10, 2, v8
    v_mul_u32_u24 v10, 896, v10
    v_and_b32 v8, 3, v8
    v_lshlrev_b32 v8, 4, v8
    v_add3_u32 v9, v9, v10, v8
    s_add_u32 m0, s12, 8192
    s_nop 0
    buffer_load_dwordx4 v9, s[44:47], s11 offen lds
    s_lshl_b32 s12, s5, 10
    s_mov_b32 s75, 1
    s_branch L_s6j_49
L_s6no_48:
    s_waitcnt vmcnt(8)
    s_barrier
    ds_read_b128 v[160:163], v26 offset:49152
    ds_read_b64_tr_b16 v[128:129], v18 offset:49152
    ds_read_b64_tr_b16 v[130:131], v18 offset:49664
    ds_read_b64_tr_b16 v[132:133], v19 offset:49152
    ds_read_b64_tr_b16 v[134:135], v19 offset:49664
    ds_read_b128 v[164:167], v27 offset:49152
    ds_read_b64_tr_b16 v[136:137], v18 offset:53248
    ds_read_b64_tr_b16 v[138:139], v18 offset:53760
    ds_read_b64_tr_b16 v[140:141], v19 offset:53248
    ds_read_b64_tr_b16 v[142:143], v19 offset:53760
    ds_read_b128 v[168:171], v28 offset:49152
    ds_read_b64_tr_b16 v[144:145], v18 offset:57344
    ds_read_b64_tr_b16 v[146:147], v18 offset:57856
    ds_read_b64_tr_b16 v[148:149], v19 offset:57344
    ds_read_b64_tr_b16 v[150:151], v19 offset:57856
    buffer_load_dwordx2 v[40:41], v13, s[48:51], 0 offen
    buffer_load_dwordx2 v[42:43], v13, s[48:51], 0 offen offset:32
    buffer_load_dwordx2 v[44:45], v13, s[56:59], 0 offen
    buffer_load_dwordx2 v[46:47], v13, s[56:59], 0 offen offset:32
    s_waitcnt lgkmcnt(10)
    v_mfma_f32_16x16x32_bf16 v[184:187], v[128:131], v[160:163], v[184:187]
    v_mfma_f32_16x16x32_bf16 v[188:191], v[132:135], v[160:163], v[188:191]
    ds_read_b128 v[160:163], v29 offset:49152
    ds_read_b64_tr_b16 v[128:129], v18 offset:61440
    ds_read_b64_tr_b16 v[130:131], v18 offset:61952
    ds_read_b64_tr_b16 v[132:133], v19 offset:61440
    ds_read_b64_tr_b16 v[134:135], v19 offset:61952
    s_waitcnt lgkmcnt(10)
    v_mfma_f32_16x16x32_bf16 v[184:187], v[136:139], v[164:167], v[184:187]
    v_mfma_f32_16x16x32_bf16 v[188:191], v[140:143], v[164:167], v[188:191]
    s_waitcnt lgkmcnt(5)
    v_mfma_f32_16x16x32_bf16 v[184:187], v[144:147], v[168:171], v[184:187]
    v_mfma_f32_16x16x32_bf16 v[188:191], v[148:151], v[168:171], v[188:191]
    s_waitcnt lgkmcnt(0)
    v_mfma_f32_16x16x32_bf16 v[184:187], v[128:131], v[160:163], v[184:187]
    v_mfma_f32_16x16x32_bf16 v[188:191], v[132:135], v[160:163], v[188:191]
    s_waitcnt vmcnt(8)
    s_barrier
    ds_read_b128 v[160:163], v26 offset:0
    ds_read_b64_tr_b16 v[128:129], v18 offset:0
    ds_read_b64_tr_b16 v[130:131], v18 offset:512
    ds_read_b64_tr_b16 v[132:133], v19 offset:0
    ds_read_b64_tr_b16 v[134:135], v19 offset:512
    ds_read_b128 v[164:167], v27 offset:0
    ds_read_b64_tr_b16 v[136:137], v18 offset:4096
    ds_read_b64_tr_b16 v[138:139], v18 offset:4608
    ds_read_b64_tr_b16 v[140:141], v19 offset:4096
    ds_read_b64_tr_b16 v[142:143], v19 offset:4608
    ds_read_b128 v[168:171], v28 offset:0
    ds_read_b64_tr_b16 v[144:145], v18 offset:8192
    ds_read_b64_tr_b16 v[146:147], v18 offset:8704
    ds_read_b64_tr_b16 v[148:149], v19 offset:8192
    ds_read_b64_tr_b16 v[150:151], v19 offset:8704
    s_waitcnt lgkmcnt(10)
    v_mfma_f32_16x16x32_bf16 v[184:187], v[128:131], v[160:163], v[184:187]
    v_mfma_f32_16x16x32_bf16 v[188:191], v[132:135], v[160:163], v[188:191]
    ds_read_b128 v[160:163], v29 offset:0
    ds_read_b64_tr_b16 v[128:129], v18 offset:12288
    ds_read_b64_tr_b16 v[130:131], v18 offset:12800
    ds_read_b64_tr_b16 v[132:133], v19 offset:12288
    ds_read_b64_tr_b16 v[134:135], v19 offset:12800
    s_waitcnt lgkmcnt(10)
    v_mfma_f32_16x16x32_bf16 v[184:187], v[136:139], v[164:167], v[184:187]
    v_mfma_f32_16x16x32_bf16 v[188:191], v[140:143], v[164:167], v[188:191]
    s_waitcnt lgkmcnt(5)
    v_mfma_f32_16x16x32_bf16 v[184:187], v[144:147], v[168:171], v[184:187]
    v_mfma_f32_16x16x32_bf16 v[188:191], v[148:151], v[168:171], v[188:191]
    s_waitcnt lgkmcnt(0)
    v_mfma_f32_16x16x32_bf16 v[184:187], v[128:131], v[160:163], v[184:187]
    v_mfma_f32_16x16x32_bf16 v[188:191], v[132:135], v[160:163], v[188:191]
    s_waitcnt vmcnt(4)
    s_barrier
    ds_read_b128 v[160:163], v26 offset:16384
    ds_read_b64_tr_b16 v[128:129], v18 offset:16384
    ds_read_b64_tr_b16 v[130:131], v18 offset:16896
    ds_read_b64_tr_b16 v[132:133], v19 offset:16384
    ds_read_b64_tr_b16 v[134:135], v19 offset:16896
    ds_read_b128 v[164:167], v27 offset:16384
    ds_read_b64_tr_b16 v[136:137], v18 offset:20480
    ds_read_b64_tr_b16 v[138:139], v18 offset:20992
    ds_read_b64_tr_b16 v[140:141], v19 offset:20480
    ds_read_b64_tr_b16 v[142:143], v19 offset:20992
    ds_read_b128 v[168:171], v28 offset:16384
    ds_read_b64_tr_b16 v[144:145], v18 offset:24576
    ds_read_b64_tr_b16 v[146:147], v18 offset:25088
    ds_read_b64_tr_b16 v[148:149], v19 offset:24576
    ds_read_b64_tr_b16 v[150:151], v19 offset:25088
    s_waitcnt lgkmcnt(10)
    v_mfma_f32_16x16x32_bf16 v[184:187], v[128:131], v[160:163], v[184:187]
    v_mfma_f32_16x16x32_bf16 v[188:191], v[132:135], v[160:163], v[188:191]
    ds_read_b128 v[160:163], v29 offset:16384
    ds_read_b64_tr_b16 v[128:129], v18 offset:28672
    ds_read_b64_tr_b16 v[130:131], v18 offset:29184
    ds_read_b64_tr_b16 v[132:133], v19 offset:28672
    ds_read_b64_tr_b16 v[134:135], v19 offset:29184
    s_waitcnt lgkmcnt(10)
    v_mfma_f32_16x16x32_bf16 v[184:187], v[136:139], v[164:167], v[184:187]
    v_mfma_f32_16x16x32_bf16 v[188:191], v[140:143], v[164:167], v[188:191]
    s_waitcnt lgkmcnt(5)
    v_mfma_f32_16x16x32_bf16 v[184:187], v[144:147], v[168:171], v[184:187]
    v_mfma_f32_16x16x32_bf16 v[188:191], v[148:151], v[168:171], v[188:191]
    s_waitcnt lgkmcnt(0)
    v_mfma_f32_16x16x32_bf16 v[184:187], v[128:131], v[160:163], v[184:187]
    v_mfma_f32_16x16x32_bf16 v[188:191], v[132:135], v[160:163], v[188:191]
L_s6j_49:
    s_waitcnt vmcnt(0)
    v_lshlrev_b32 v212, 16, v40
    v_and_b32 v213, 0xffff0000, v40
    v_lshlrev_b32 v214, 16, v41
    v_and_b32 v215, 0xffff0000, v41
    v_lshlrev_b32 v216, 16, v42
    v_and_b32 v217, 0xffff0000, v42
    v_lshlrev_b32 v218, 16, v43
    v_and_b32 v219, 0xffff0000, v43
    v_add_f32 v184, v184, v212
    v_add_f32 v185, v185, v213
    v_add_f32 v186, v186, v214
    v_add_f32 v187, v187, v215
    v_add_f32 v188, v188, v216
    v_add_f32 v189, v189, v217
    v_add_f32 v190, v190, v218
    v_add_f32 v191, v191, v219
    v_lshlrev_b32 v212, 16, v44
    v_and_b32 v213, 0xffff0000, v44
    v_lshlrev_b32 v214, 16, v45
    v_and_b32 v215, 0xffff0000, v45
    v_lshlrev_b32 v216, 16, v46
    v_and_b32 v217, 0xffff0000, v46
    v_lshlrev_b32 v218, 16, v47
    v_and_b32 v219, 0xffff0000, v47
    v_add_f32 v184, v184, v212
    v_add_f32 v185, v185, v213
    v_add_f32 v186, v186, v214
    v_add_f32 v187, v187, v215
    v_add_f32 v188, v188, v216
    v_add_f32 v189, v189, v217
    v_add_f32 v190, v190, v218
    v_add_f32 v191, v191, v219
    v_cvt_pk_bf16_f32 v220, v184, v185
    v_cvt_pk_bf16_f32 v221, v186, v187
    v_cvt_pk_bf16_f32 v222, v188, v189
    v_cvt_pk_bf16_f32 v223, v190, v191
    v_lshlrev_b32 v14, 3, v3
    v_sub_u32 v14, v13, v14
    v_and_b32 v245, 1, v3
    v_lshl_add_u32 v14, v245, 5, v14
    v_lshrrev_b32 v245, 1, v3
    v_lshl_add_u32 v14, v245, 4, v14
    v_permlane16_swap_b32 v220, v222
    v_permlane16_swap_b32 v221, v223
    buffer_store_dwordx4 v[220:223], v14, s[52:55], 0 offen sc1
    s_waitcnt vmcnt(0) lgkmcnt(0)
    s_barrier
    s_cmp_lg_u32 s5, 0
    s_cbranch_scc1 L_sig_50
    v_mov_b32 v8, s6
    s_lshl_b32 s10, s64, 3
    s_add_u32 s10, s10, 6
    s_lshl_b32 s10, s10, 12
    s_lshl_b32 s11, s7, 3
    s_add_u32 s10, s10, s11
    v_lshlrev_b32 v8, 7, v8
    v_add_u32 v8, s10, v8
    v_mov_b32 v10, s90
    v_mov_b32 v11, s91
    s_mov_b64 exec, 1
    buffer_store_dwordx2 v[10:11], v8, s[92:95], 0 offen sc1
    s_mov_b64 exec, -1
L_sig_50:
    s_cmp_eq_u32 s75, 0
    s_cbranch_scc1 L_s6r_51
    s_mul_i32 s11, s4, 56
    s_lshl_b32 s12, s5, 10
    s_add_u32 s12, s12, 65536
    s_lshl_b32 s10, s5, 6
    v_add_u32 v12, s10, v1
    v_add_u32 v8, 1024, v12
    v_mul_u32_u24 v9, 2731, v8
    v_lshrrev_b32 v9, 15, v9
    v_mul_u32_u24 v10, 12, v9
    v_sub_u32 v8, v8, v10
    v_bfe_u32 v10, v9, 3, 1
    v_lshlrev_b32 v10, 1, v10
    v_xor_b32 v8, v8, v10
    s_mov_b32 s10, 2688
    v_mul_lo_u32 v9, v9, s10
    v_lshrrev_b32 v10, 2, v8
    v_mul_u32_u24 v10, 896, v10
    v_and_b32 v8, 3, v8
    v_lshlrev_b32 v8, 4, v8
    v_add3_u32 v9, v9, v10, v8
    s_add_u32 m0, s12, 16384
    s_nop 0
    buffer_load_dwordx4 v9, s[44:47], s11 offen lds
    v_add_u32 v8, 1536, v12
    v_mul_u32_u24 v9, 2731, v8
    v_lshrrev_b32 v9, 15, v9
    v_mul_u32_u24 v10, 12, v9
    v_sub_u32 v8, v8, v10
    v_bfe_u32 v10, v9, 3, 1
    v_lshlrev_b32 v10, 1, v10
    v_xor_b32 v8, v8, v10
    s_mov_b32 s10, 2688
    v_mul_lo_u32 v9, v9, s10
    v_lshrrev_b32 v10, 2, v8
    v_mul_u32_u24 v10, 896, v10
    v_and_b32 v8, 3, v8
    v_lshlrev_b32 v8, 4, v8
    v_add3_u32 v9, v9, v10, v8
    s_add_u32 m0, s12, 24576
    s_nop 0
    buffer_load_dwordx4 v9, s[44:47], s11 offen lds
    s_cmp_ge_u32 s5, 4
    s_cbranch_scc1 L_wdg_52
    v_add_u32 v8, 5120, v12
    v_mul_u32_u24 v9, 2731, v8
    v_lshrrev_b32 v9, 15, v9
    v_mul_u32_u24 v10, 12, v9
    v_sub_u32 v8, v8, v10
    v_bfe_u32 v10, v9, 3, 1
    v_lshlrev_b32 v10, 1, v10
    v_xor_b32 v8, v8, v10
    s_mov_b32 s10, 2688
    v_mul_lo_u32 v9, v9, s10
    v_lshrrev_b32 v10, 2, v8
    v_mul_u32_u24 v10, 896, v10
    v_and_b32 v8, 3, v8
    v_lshlrev_b32 v8, 4, v8
    v_add3_u32 v9, v9, v10, v8
    s_add_u32 m0, s12, 81920
    s_nop 0
    buffer_load_dwordx4 v9, s[44:47], s11 offen lds
L_wdg_52:
L_s6r_51:
L_skipB_45:
    s_add_u32 s64, s64, 1
    s_cmp_lt_u32 s64, 2
    s_nop 12
    s_cbranch_scc1 L_layer
L_abort:
L_end:
    s_endpgm
.section .rodata,"a"
.p2align 6
.amdhsa_kernel interleave_layers__linear_kernel_hedgehog__mixer_s_mlp__prompt_kernel
  .amdhsa_next_free_vgpr 256
  .amdhsa_next_free_sgpr 100
  .amdhsa_accum_offset 256
  .amdhsa_group_segment_fixed_size 0
  .amdhsa_kernarg_size 96
  .amdhsa_user_sgpr_count 2
  .amdhsa_user_sgpr_kernarg_segment_ptr 1
  .amdhsa_system_sgpr_workgroup_id_x 1
.end_amdhsa_kernel
```
